```python
import torch

def _softmax(x, axis=-1):
    return torch.softmax(x, dim=axis)
def _gelu(x):
    return torch.nn.functional.gelu(x, approximate="tanh")
def _silu(x):
    return torch.nn.functional.silu(x)
def _sigmoid(x):
    return torch.sigmoid(x)
def _layernorm(x, axis=-1, eps=1e-5):
    m = x.mean(dim=axis, keepdim=True)
    v = x.var(dim=axis, keepdim=True, unbiased=False)
    return (x - m) / torch.sqrt(v + eps)
def _scatter_add(tgt, idx, src, axis=0):
    return tgt.clone().index_add_(axis, idx, src)
def _segment_sum(src, seg, n):
    out = torch.zeros((n,) + src.shape[1:], dtype=src.dtype)
    return out.index_add_(0, seg, src)
def _pad(x, pw):
    flat = tuple(v for pair in reversed(pw) for v in pair)
    return torch.nn.functional.pad(x, flat)

kernel_name = 'standalone__kernel_systems_refs_ge_spmm__graph'

def setup_inputs():

    _w = (lambda a: (lambda t: t.to(torch.bfloat16) if t.is_floating_point() else t)(torch.as_tensor(a)))
    N, deg, D = 50000, 16, 64
    E = N * deg
    src = (lambda lo, hi, *s: torch.randint(lo, hi, s))(0, N, E).to(torch.int64)
    dst = (lambda lo, hi, *s: torch.randint(lo, hi, s))(0, N, E).to(torch.int64)
    e_w = (lambda *s: torch.randn(*s, dtype=torch.bfloat16) * 0.05)(E).to(float)
    return {
        "x": _w((lambda *s: torch.randn(*s, dtype=torch.bfloat16) * 0.05)(N, D).to(float)),
        "src": _w(src),
        "dst": _w(dst),
        "e_w": _w(e_w),
        "w": _w((lambda *s: torch.randn(*s, dtype=torch.bfloat16) * 0.05)(D, D).to(float)),
    }

def reference(x, src, dst, e_w, w):
    N = x.shape[0]
    h = x @ w
    msg = e_w[:, None] * h[src]
    return _segment_sum(msg, dst, N)
```

```asm
; @launch kernel=spmm_k1_kernel grid=(392,1,1) block=(256,1,1) lds=37120
; @launch kernel=spmm_k2_kernel grid=(782,1,1) block=(512,1,1) lds=28672
.amdgcn_target "amdgcn-amd-amdhsa--gfx950"
.text
.globl spmm_k1_kernel
.p2align 8
.type spmm_k1_kernel,@function
spmm_k1_kernel:
s_cmp_ge_u32 s2, 392
s_cbranch_scc1 K1_END
s_load_dwordx4 s[4:7], s[0:1], 0
s_load_dwordx4 s[8:11], s[0:1], 16
s_load_dwordx2 s[12:13], s[0:1], 32
s_load_dwordx2 s[14:15], s[0:1], 56
s_waitcnt lgkmcnt(0)
s_cmp_ge_u32 s2, 196
s_cbranch_scc1 K1_GEMM
s_mov_b32 s16, s8
s_mov_b32 s17, s9
s_mov_b32 s18, 0x30d400
s_mov_b32 s19, 0x00020000
s_mov_b32 s20, s6
s_mov_b32 s21, s7
s_mov_b32 s22, 0x30d400
s_mov_b32 s23, 0x00020000
s_mov_b32 s24, s10
s_mov_b32 s25, s11
s_mov_b32 s26, 0x186a00
s_mov_b32 s27, 0x00020000
s_add_u32 s28, s14, 0x800000
s_addc_u32 s29, s15, 0
s_mov_b32 s30, 0x620000
s_mov_b32 s31, 0x00020000
s_add_u32 s32, s14, 0x1000000
s_addc_u32 s33, s15, 0
s_mov_b32 s34, 0xc4000
s_mov_b32 s35, 0x00020000
s_lshl_b32 s36, s2, 12
v_lshlrev_b32 v1, 2, v0
v_add_u32 v1, s36, v1
v_lshlrev_b32 v2, 2, v1
v_lshlrev_b32 v3, 1, v1
v_mov_b32 v4, 0
v_mov_b32 v5, 0
v_mov_b32 v6, 0
v_mov_b32 v7, 0
v_lshlrev_b32 v8, 4, v0
ds_write_b128 v8, v[4:7] offset:0
s_mov_b32 s37, 4096
s_mov_b32 s38, 8192
s_mov_b32 s39, 12288
s_mov_b32 s40, 2048
s_mov_b32 s41, 4096
s_mov_b32 s42, 6144
buffer_load_dwordx4 v[12:15], v2, s[16:19], 0 offen
buffer_load_dwordx4 v[16:19], v2, s[16:19], s37 offen
buffer_load_dwordx4 v[20:23], v2, s[16:19], s38 offen
buffer_load_dwordx4 v[24:27], v2, s[16:19], s39 offen
buffer_load_dwordx4 v[28:31], v2, s[20:23], 0 offen
buffer_load_dwordx4 v[32:35], v2, s[20:23], s37 offen
buffer_load_dwordx4 v[36:39], v2, s[20:23], s38 offen
buffer_load_dwordx4 v[40:43], v2, s[20:23], s39 offen
buffer_load_dwordx2 v[44:45], v3, s[24:27], 0 offen
buffer_load_dwordx2 v[46:47], v3, s[24:27], s40 offen
buffer_load_dwordx2 v[48:49], v3, s[24:27], s41 offen
buffer_load_dwordx2 v[50:51], v3, s[24:27], s42 offen
s_mov_b32 s43, 0xffff0000
v_mov_b32 v9, 1
v_mov_b32 v10, 1023
s_waitcnt lgkmcnt(0)
s_barrier
s_waitcnt vmcnt(0)
v_add_u32 v11, 0, v1
v_cmp_gt_u32 vcc, 800000, v11
v_lshrrev_b32 v52, 6, v12
v_and_b32 v12, 63, v12
v_cndmask_b32 v52, v10, v52, vcc
v_lshlrev_b32 v52, 2, v52
v_lshl_or_b32 v28, v44, 16, v28
ds_add_rtn_u32 v68, v52, v9 offset:0
v_lshrrev_b32 v53, 6, v13
v_and_b32 v13, 63, v13
v_cndmask_b32 v53, v10, v53, vcc
v_lshlrev_b32 v53, 2, v53
v_and_or_b32 v29, v44, s43, v29
ds_add_rtn_u32 v69, v53, v9 offset:0
v_lshrrev_b32 v54, 6, v14
v_and_b32 v14, 63, v14
v_cndmask_b32 v54, v10, v54, vcc
v_lshlrev_b32 v54, 2, v54
v_lshl_or_b32 v30, v45, 16, v30
ds_add_rtn_u32 v70, v54, v9 offset:0
v_lshrrev_b32 v55, 6, v15
v_and_b32 v15, 63, v15
v_cndmask_b32 v55, v10, v55, vcc
v_lshlrev_b32 v55, 2, v55
v_and_or_b32 v31, v45, s43, v31
ds_add_rtn_u32 v71, v55, v9 offset:0
v_add_u32 v11, 1024, v1
v_cmp_gt_u32 vcc, 800000, v11
v_lshrrev_b32 v56, 6, v16
v_and_b32 v16, 63, v16
v_cndmask_b32 v56, v10, v56, vcc
v_lshlrev_b32 v56, 2, v56
v_lshl_or_b32 v32, v46, 16, v32
ds_add_rtn_u32 v72, v56, v9 offset:0
v_lshrrev_b32 v57, 6, v17
v_and_b32 v17, 63, v17
v_cndmask_b32 v57, v10, v57, vcc
v_lshlrev_b32 v57, 2, v57
v_and_or_b32 v33, v46, s43, v33
ds_add_rtn_u32 v73, v57, v9 offset:0
v_lshrrev_b32 v58, 6, v18
v_and_b32 v18, 63, v18
v_cndmask_b32 v58, v10, v58, vcc
v_lshlrev_b32 v58, 2, v58
v_lshl_or_b32 v34, v47, 16, v34
ds_add_rtn_u32 v74, v58, v9 offset:0
v_lshrrev_b32 v59, 6, v19
v_and_b32 v19, 63, v19
v_cndmask_b32 v59, v10, v59, vcc
v_lshlrev_b32 v59, 2, v59
v_and_or_b32 v35, v47, s43, v35
ds_add_rtn_u32 v75, v59, v9 offset:0
v_add_u32 v11, 2048, v1
v_cmp_gt_u32 vcc, 800000, v11
v_lshrrev_b32 v60, 6, v20
v_and_b32 v20, 63, v20
v_cndmask_b32 v60, v10, v60, vcc
v_lshlrev_b32 v60, 2, v60
v_lshl_or_b32 v36, v48, 16, v36
ds_add_rtn_u32 v76, v60, v9 offset:0
v_lshrrev_b32 v61, 6, v21
v_and_b32 v21, 63, v21
v_cndmask_b32 v61, v10, v61, vcc
v_lshlrev_b32 v61, 2, v61
v_and_or_b32 v37, v48, s43, v37
ds_add_rtn_u32 v77, v61, v9 offset:0
v_lshrrev_b32 v62, 6, v22
v_and_b32 v22, 63, v22
v_cndmask_b32 v62, v10, v62, vcc
v_lshlrev_b32 v62, 2, v62
v_lshl_or_b32 v38, v49, 16, v38
ds_add_rtn_u32 v78, v62, v9 offset:0
v_lshrrev_b32 v63, 6, v23
v_and_b32 v23, 63, v23
v_cndmask_b32 v63, v10, v63, vcc
v_lshlrev_b32 v63, 2, v63
v_and_or_b32 v39, v49, s43, v39
ds_add_rtn_u32 v79, v63, v9 offset:0
v_add_u32 v11, 3072, v1
v_cmp_gt_u32 vcc, 800000, v11
v_lshrrev_b32 v64, 6, v24
v_and_b32 v24, 63, v24
v_cndmask_b32 v64, v10, v64, vcc
v_lshlrev_b32 v64, 2, v64
v_lshl_or_b32 v40, v50, 16, v40
ds_add_rtn_u32 v80, v64, v9 offset:0
v_lshrrev_b32 v65, 6, v25
v_and_b32 v25, 63, v25
v_cndmask_b32 v65, v10, v65, vcc
v_lshlrev_b32 v65, 2, v65
v_and_or_b32 v41, v50, s43, v41
ds_add_rtn_u32 v81, v65, v9 offset:0
v_lshrrev_b32 v66, 6, v26
v_and_b32 v26, 63, v26
v_cndmask_b32 v66, v10, v66, vcc
v_lshlrev_b32 v66, 2, v66
v_lshl_or_b32 v42, v51, 16, v42
ds_add_rtn_u32 v82, v66, v9 offset:0
v_lshrrev_b32 v67, 6, v27
v_and_b32 v27, 63, v27
v_cndmask_b32 v67, v10, v67, vcc
v_lshlrev_b32 v67, 2, v67
v_and_or_b32 v43, v51, s43, v43
ds_add_rtn_u32 v83, v67, v9 offset:0
s_waitcnt lgkmcnt(0)
s_barrier
ds_read_b128 v[4:7], v8 offset:0
s_waitcnt lgkmcnt(0)
v_add_u32 v11, v4, v5
v_add_u32 v11, v11, v6
v_add_u32 v11, v11, v7
v_mov_b32 v84, v11
s_nop 1
v_add_u32_dpp v84, v84, v84 row_shr:1 row_mask:0xf bank_mask:0xf bound_ctrl:0
s_nop 1
v_add_u32_dpp v84, v84, v84 row_shr:2 row_mask:0xf bank_mask:0xf bound_ctrl:0
s_nop 1
v_add_u32_dpp v84, v84, v84 row_shr:4 row_mask:0xf bank_mask:0xf bound_ctrl:0
s_nop 1
v_add_u32_dpp v84, v84, v84 row_shr:8 row_mask:0xf bank_mask:0xf bound_ctrl:0
s_nop 1
v_add_u32_dpp v84, v84, v84 row_bcast:15 row_mask:0xa bank_mask:0xf
s_nop 1
v_add_u32_dpp v84, v84, v84 row_bcast:31 row_mask:0xc bank_mask:0xf
s_nop 1
v_and_b32 v85, 63, v0
v_lshrrev_b32 v86, 6, v0
v_lshlrev_b32 v87, 2, v86
v_cmp_eq_u32 vcc, 63, v85
s_and_saveexec_b64 s[44:45], vcc
ds_write_b32 v87, v84 offset:4096
s_mov_b64 exec, s[44:45]
s_waitcnt lgkmcnt(0)
s_barrier
v_mov_b32 v88, 0
ds_read_b128 v[88:91], v88 offset:4096
v_readfirstlane_b32 s46, v86
s_waitcnt lgkmcnt(0)
v_sub_u32 v84, v84, v11
s_cmp_gt_u32 s46, 0
s_cselect_b32 s47, 1, 0
v_mul_lo_u32 v92, v88, s47
v_add_u32 v84, v84, v92
s_cmp_gt_u32 s46, 1
s_cselect_b32 s47, 1, 0
v_mul_lo_u32 v92, v89, s47
v_add_u32 v84, v84, v92
s_cmp_gt_u32 s46, 2
s_cselect_b32 s47, 1, 0
v_mul_lo_u32 v92, v90, s47
v_add_u32 v84, v84, v92
v_mov_b32 v92, v84
v_add_u32 v93, v92, v4
v_add_u32 v94, v93, v5
v_add_u32 v95, v94, v6
ds_write_b128 v8, v[92:95] offset:0
s_lshl_b32 s47, s2, 12
buffer_store_dwordx4 v[92:95], v8, s[32:35], s47 offen
s_waitcnt lgkmcnt(0)
s_barrier
ds_read_b32 v52, v52 offset:0
ds_read_b32 v53, v53 offset:0
ds_read_b32 v54, v54 offset:0
ds_read_b32 v55, v55 offset:0
ds_read_b32 v56, v56 offset:0
ds_read_b32 v57, v57 offset:0
ds_read_b32 v58, v58 offset:0
ds_read_b32 v59, v59 offset:0
ds_read_b32 v60, v60 offset:0
ds_read_b32 v61, v61 offset:0
ds_read_b32 v62, v62 offset:0
ds_read_b32 v63, v63 offset:0
ds_read_b32 v64, v64 offset:0
ds_read_b32 v65, v65 offset:0
ds_read_b32 v66, v66 offset:0
ds_read_b32 v67, v67 offset:0
s_waitcnt lgkmcnt(0)
v_add_u32 v52, v52, v68
v_lshlrev_b32 v52, 3, v52
v_add_u32 v52, 4352, v52
ds_write2_b32 v52, v28, v12 offset0:0 offset1:1
v_add_u32 v53, v53, v69
v_lshlrev_b32 v53, 3, v53
v_add_u32 v53, 4352, v53
ds_write2_b32 v53, v29, v13 offset0:0 offset1:1
v_add_u32 v54, v54, v70
v_lshlrev_b32 v54, 3, v54
v_add_u32 v54, 4352, v54
ds_write2_b32 v54, v30, v14 offset0:0 offset1:1
v_add_u32 v55, v55, v71
v_lshlrev_b32 v55, 3, v55
v_add_u32 v55, 4352, v55
ds_write2_b32 v55, v31, v15 offset0:0 offset1:1
v_add_u32 v56, v56, v72
v_lshlrev_b32 v56, 3, v56
v_add_u32 v56, 4352, v56
ds_write2_b32 v56, v32, v16 offset0:0 offset1:1
v_add_u32 v57, v57, v73
v_lshlrev_b32 v57, 3, v57
v_add_u32 v57, 4352, v57
ds_write2_b32 v57, v33, v17 offset0:0 offset1:1
v_add_u32 v58, v58, v74
v_lshlrev_b32 v58, 3, v58
v_add_u32 v58, 4352, v58
ds_write2_b32 v58, v34, v18 offset0:0 offset1:1
v_add_u32 v59, v59, v75
v_lshlrev_b32 v59, 3, v59
v_add_u32 v59, 4352, v59
ds_write2_b32 v59, v35, v19 offset0:0 offset1:1
v_add_u32 v60, v60, v76
v_lshlrev_b32 v60, 3, v60
v_add_u32 v60, 4352, v60
ds_write2_b32 v60, v36, v20 offset0:0 offset1:1
v_add_u32 v61, v61, v77
v_lshlrev_b32 v61, 3, v61
v_add_u32 v61, 4352, v61
ds_write2_b32 v61, v37, v21 offset0:0 offset1:1
v_add_u32 v62, v62, v78
v_lshlrev_b32 v62, 3, v62
v_add_u32 v62, 4352, v62
ds_write2_b32 v62, v38, v22 offset0:0 offset1:1
v_add_u32 v63, v63, v79
v_lshlrev_b32 v63, 3, v63
v_add_u32 v63, 4352, v63
ds_write2_b32 v63, v39, v23 offset0:0 offset1:1
v_add_u32 v64, v64, v80
v_lshlrev_b32 v64, 3, v64
v_add_u32 v64, 4352, v64
ds_write2_b32 v64, v40, v24 offset0:0 offset1:1
v_add_u32 v65, v65, v81
v_lshlrev_b32 v65, 3, v65
v_add_u32 v65, 4352, v65
ds_write2_b32 v65, v41, v25 offset0:0 offset1:1
v_add_u32 v66, v66, v82
v_lshlrev_b32 v66, 3, v66
v_add_u32 v66, 4352, v66
ds_write2_b32 v66, v42, v26 offset0:0 offset1:1
v_add_u32 v67, v67, v83
v_lshlrev_b32 v67, 3, v67
v_add_u32 v67, 4352, v67
ds_write2_b32 v67, v43, v27 offset0:0 offset1:1
s_waitcnt lgkmcnt(0)
s_barrier
s_lshl_b32 s47, s2, 15
ds_read_b128 v[12:15], v8 offset:4352
ds_read_b128 v[16:19], v8 offset:8448
ds_read_b128 v[20:23], v8 offset:12544
ds_read_b128 v[24:27], v8 offset:16640
ds_read_b128 v[28:31], v8 offset:20736
ds_read_b128 v[32:35], v8 offset:24832
ds_read_b128 v[36:39], v8 offset:28928
ds_read_b128 v[40:43], v8 offset:33024
s_waitcnt lgkmcnt(7)
buffer_store_dwordx4 v[12:15], v8, s[28:31], s47 offen offset:0
s_waitcnt lgkmcnt(6)
s_add_u32 s48, s47, 4096
buffer_store_dwordx4 v[16:19], v8, s[28:31], s48 offen
s_waitcnt lgkmcnt(5)
s_add_u32 s48, s47, 8192
buffer_store_dwordx4 v[20:23], v8, s[28:31], s48 offen
s_waitcnt lgkmcnt(4)
s_add_u32 s48, s47, 12288
buffer_store_dwordx4 v[24:27], v8, s[28:31], s48 offen
s_waitcnt lgkmcnt(3)
s_add_u32 s48, s47, 16384
buffer_store_dwordx4 v[28:31], v8, s[28:31], s48 offen
s_waitcnt lgkmcnt(2)
s_add_u32 s48, s47, 20480
buffer_store_dwordx4 v[32:35], v8, s[28:31], s48 offen
s_waitcnt lgkmcnt(1)
s_add_u32 s48, s47, 24576
buffer_store_dwordx4 v[36:39], v8, s[28:31], s48 offen
s_waitcnt lgkmcnt(0)
s_add_u32 s48, s47, 28672
buffer_store_dwordx4 v[40:43], v8, s[28:31], s48 offen
s_endpgm
K1_GEMM:
s_mov_b32 s16, s4
s_mov_b32 s17, s5
s_mov_b32 s18, 0x61a800
s_mov_b32 s19, 0x00020000
s_mov_b32 s20, s12
s_mov_b32 s21, s13
s_mov_b32 s22, 0x2000
s_mov_b32 s23, 0x00020000
s_mov_b32 s24, s14
s_mov_b32 s25, s15
s_mov_b32 s26, 0x61a800
s_mov_b32 s27, 0x00020000
s_sub_u32 s28, s2, 196
v_and_b32 v1, 31, v0
v_and_b32 v2, 63, v0
v_lshrrev_b32 v2, 5, v2
v_lshrrev_b32 v3, 6, v0
v_lshlrev_b32 v4, 10, v2
v_lshl_add_u32 v4, v1, 1, v4
s_mov_b32 s29, 4096
buffer_load_ushort v16, v4, s[20:23], 0 offen offset:0
buffer_load_ushort v48, v4, s[20:23], 0 offen offset:128
buffer_load_ushort v17, v4, s[20:23], 0 offen offset:256
buffer_load_ushort v49, v4, s[20:23], 0 offen offset:384
buffer_load_ushort v18, v4, s[20:23], 0 offen offset:512
buffer_load_ushort v50, v4, s[20:23], 0 offen offset:640
buffer_load_ushort v19, v4, s[20:23], 0 offen offset:768
buffer_load_ushort v51, v4, s[20:23], 0 offen offset:896
buffer_load_ushort v20, v4, s[20:23], 0 offen offset:2048
buffer_load_ushort v52, v4, s[20:23], 0 offen offset:2176
buffer_load_ushort v21, v4, s[20:23], 0 offen offset:2304
buffer_load_ushort v53, v4, s[20:23], 0 offen offset:2432
buffer_load_ushort v22, v4, s[20:23], 0 offen offset:2560
buffer_load_ushort v54, v4, s[20:23], 0 offen offset:2688
buffer_load_ushort v23, v4, s[20:23], 0 offen offset:2816
buffer_load_ushort v55, v4, s[20:23], 0 offen offset:2944
buffer_load_ushort v24, v4, s[20:23], s29 offen offset:0
buffer_load_ushort v56, v4, s[20:23], s29 offen offset:128
buffer_load_ushort v25, v4, s[20:23], s29 offen offset:256
buffer_load_ushort v57, v4, s[20:23], s29 offen offset:384
buffer_load_ushort v26, v4, s[20:23], s29 offen offset:512
buffer_load_ushort v58, v4, s[20:23], s29 offen offset:640
buffer_load_ushort v27, v4, s[20:23], s29 offen offset:768
buffer_load_ushort v59, v4, s[20:23], s29 offen offset:896
buffer_load_ushort v28, v4, s[20:23], s29 offen offset:2048
buffer_load_ushort v60, v4, s[20:23], s29 offen offset:2176
buffer_load_ushort v29, v4, s[20:23], s29 offen offset:2304
buffer_load_ushort v61, v4, s[20:23], s29 offen offset:2432
buffer_load_ushort v30, v4, s[20:23], s29 offen offset:2560
buffer_load_ushort v62, v4, s[20:23], s29 offen offset:2688
buffer_load_ushort v31, v4, s[20:23], s29 offen offset:2816
buffer_load_ushort v63, v4, s[20:23], s29 offen offset:2944
buffer_load_ushort v32, v4, s[20:23], 0 offen offset:64
buffer_load_ushort v64, v4, s[20:23], 0 offen offset:192
buffer_load_ushort v33, v4, s[20:23], 0 offen offset:320
buffer_load_ushort v65, v4, s[20:23], 0 offen offset:448
buffer_load_ushort v34, v4, s[20:23], 0 offen offset:576
buffer_load_ushort v66, v4, s[20:23], 0 offen offset:704
buffer_load_ushort v35, v4, s[20:23], 0 offen offset:832
buffer_load_ushort v67, v4, s[20:23], 0 offen offset:960
buffer_load_ushort v36, v4, s[20:23], 0 offen offset:2112
buffer_load_ushort v68, v4, s[20:23], 0 offen offset:2240
buffer_load_ushort v37, v4, s[20:23], 0 offen offset:2368
buffer_load_ushort v69, v4, s[20:23], 0 offen offset:2496
buffer_load_ushort v38, v4, s[20:23], 0 offen offset:2624
buffer_load_ushort v70, v4, s[20:23], 0 offen offset:2752
buffer_load_ushort v39, v4, s[20:23], 0 offen offset:2880
buffer_load_ushort v71, v4, s[20:23], 0 offen offset:3008
buffer_load_ushort v40, v4, s[20:23], s29 offen offset:64
buffer_load_ushort v72, v4, s[20:23], s29 offen offset:192
buffer_load_ushort v41, v4, s[20:23], s29 offen offset:320
buffer_load_ushort v73, v4, s[20:23], s29 offen offset:448
buffer_load_ushort v42, v4, s[20:23], s29 offen offset:576
buffer_load_ushort v74, v4, s[20:23], s29 offen offset:704
buffer_load_ushort v43, v4, s[20:23], s29 offen offset:832
buffer_load_ushort v75, v4, s[20:23], s29 offen offset:960
buffer_load_ushort v44, v4, s[20:23], s29 offen offset:2112
buffer_load_ushort v76, v4, s[20:23], s29 offen offset:2240
buffer_load_ushort v45, v4, s[20:23], s29 offen offset:2368
buffer_load_ushort v77, v4, s[20:23], s29 offen offset:2496
buffer_load_ushort v46, v4, s[20:23], s29 offen offset:2624
buffer_load_ushort v78, v4, s[20:23], s29 offen offset:2752
buffer_load_ushort v47, v4, s[20:23], s29 offen offset:2880
buffer_load_ushort v79, v4, s[20:23], s29 offen offset:3008
s_waitcnt vmcnt(0)
v_lshl_or_b32 v16, v48, 16, v16
v_lshl_or_b32 v17, v49, 16, v17
v_lshl_or_b32 v18, v50, 16, v18
v_lshl_or_b32 v19, v51, 16, v19
v_lshl_or_b32 v20, v52, 16, v20
v_lshl_or_b32 v21, v53, 16, v21
v_lshl_or_b32 v22, v54, 16, v22
v_lshl_or_b32 v23, v55, 16, v23
v_lshl_or_b32 v24, v56, 16, v24
v_lshl_or_b32 v25, v57, 16, v25
v_lshl_or_b32 v26, v58, 16, v26
v_lshl_or_b32 v27, v59, 16, v27
v_lshl_or_b32 v28, v60, 16, v28
v_lshl_or_b32 v29, v61, 16, v29
v_lshl_or_b32 v30, v62, 16, v30
v_lshl_or_b32 v31, v63, 16, v31
v_lshl_or_b32 v32, v64, 16, v32
v_lshl_or_b32 v33, v65, 16, v33
v_lshl_or_b32 v34, v66, 16, v34
v_lshl_or_b32 v35, v67, 16, v35
v_lshl_or_b32 v36, v68, 16, v36
v_lshl_or_b32 v37, v69, 16, v37
v_lshl_or_b32 v38, v70, 16, v38
v_lshl_or_b32 v39, v71, 16, v39
v_lshl_or_b32 v40, v72, 16, v40
v_lshl_or_b32 v41, v73, 16, v41
v_lshl_or_b32 v42, v74, 16, v42
v_lshl_or_b32 v43, v75, 16, v43
v_lshl_or_b32 v44, v76, 16, v44
v_lshl_or_b32 v45, v77, 16, v45
v_lshl_or_b32 v46, v78, 16, v46
v_lshl_or_b32 v47, v79, 16, v47
s_lshl_b32 s30, s28, 3
v_lshlrev_b32 v5, 1, v3
v_add_u32 v5, s30, v5
v_lshlrev_b32 v5, 5, v5
v_add_u32 v5, v5, v1
v_lshlrev_b32 v6, 7, v5
v_lshl_add_u32 v7, v2, 4, v6
v_lshl_add_u32 v8, v2, 3, v6
buffer_load_dwordx4 v[48:51], v7, s[16:19], 0 offen offset:0
buffer_load_dwordx4 v[52:55], v7, s[16:19], 0 offen offset:32
buffer_load_dwordx4 v[56:59], v7, s[16:19], 0 offen offset:64
buffer_load_dwordx4 v[60:63], v7, s[16:19], 0 offen offset:96
buffer_load_dwordx4 v[64:67], v7, s[16:19], s29 offen offset:0
buffer_load_dwordx4 v[68:71], v7, s[16:19], s29 offen offset:32
buffer_load_dwordx4 v[72:75], v7, s[16:19], s29 offen offset:64
buffer_load_dwordx4 v[76:79], v7, s[16:19], s29 offen offset:96
s_waitcnt vmcnt(0)
v_mfma_f32_32x32x16_bf16 v[80:95], v[16:19], v[48:51], 0
v_mfma_f32_32x32x16_bf16 v[80:95], v[20:23], v[52:55], v[80:95]
v_mfma_f32_32x32x16_bf16 v[80:95], v[24:27], v[56:59], v[80:95]
v_mfma_f32_32x32x16_bf16 v[80:95], v[28:31], v[60:63], v[80:95]
v_mfma_f32_32x32x16_bf16 v[96:111], v[32:35], v[48:51], 0
v_mfma_f32_32x32x16_bf16 v[96:111], v[36:39], v[52:55], v[96:111]
v_mfma_f32_32x32x16_bf16 v[96:111], v[40:43], v[56:59], v[96:111]
v_mfma_f32_32x32x16_bf16 v[96:111], v[44:47], v[60:63], v[96:111]
s_nop 7
s_nop 7
v_cvt_pk_bf16_f32 v10, v80, v81
v_cvt_pk_bf16_f32 v11, v82, v83
buffer_store_dwordx2 v[10:11], v8, s[24:27], 0 offen offset:0
s_nop 1
v_cvt_pk_bf16_f32 v10, v84, v85
v_cvt_pk_bf16_f32 v11, v86, v87
buffer_store_dwordx2 v[10:11], v8, s[24:27], 0 offen offset:16
s_nop 1
v_cvt_pk_bf16_f32 v10, v88, v89
v_cvt_pk_bf16_f32 v11, v90, v91
buffer_store_dwordx2 v[10:11], v8, s[24:27], 0 offen offset:32
s_nop 1
v_cvt_pk_bf16_f32 v10, v92, v93
v_cvt_pk_bf16_f32 v11, v94, v95
buffer_store_dwordx2 v[10:11], v8, s[24:27], 0 offen offset:48
s_nop 1
v_cvt_pk_bf16_f32 v10, v96, v97
v_cvt_pk_bf16_f32 v11, v98, v99
buffer_store_dwordx2 v[10:11], v8, s[24:27], 0 offen offset:64
s_nop 1
v_cvt_pk_bf16_f32 v10, v100, v101
v_cvt_pk_bf16_f32 v11, v102, v103
buffer_store_dwordx2 v[10:11], v8, s[24:27], 0 offen offset:80
s_nop 1
v_cvt_pk_bf16_f32 v10, v104, v105
v_cvt_pk_bf16_f32 v11, v106, v107
buffer_store_dwordx2 v[10:11], v8, s[24:27], 0 offen offset:96
s_nop 1
v_cvt_pk_bf16_f32 v10, v108, v109
v_cvt_pk_bf16_f32 v11, v110, v111
buffer_store_dwordx2 v[10:11], v8, s[24:27], 0 offen offset:112
s_nop 1
v_mfma_f32_32x32x16_bf16 v[80:95], v[16:19], v[64:67], 0
v_mfma_f32_32x32x16_bf16 v[80:95], v[20:23], v[68:71], v[80:95]
v_mfma_f32_32x32x16_bf16 v[80:95], v[24:27], v[72:75], v[80:95]
v_mfma_f32_32x32x16_bf16 v[80:95], v[28:31], v[76:79], v[80:95]
v_mfma_f32_32x32x16_bf16 v[96:111], v[32:35], v[64:67], 0
v_mfma_f32_32x32x16_bf16 v[96:111], v[36:39], v[68:71], v[96:111]
v_mfma_f32_32x32x16_bf16 v[96:111], v[40:43], v[72:75], v[96:111]
v_mfma_f32_32x32x16_bf16 v[96:111], v[44:47], v[76:79], v[96:111]
s_nop 7
s_nop 7
v_cvt_pk_bf16_f32 v10, v80, v81
v_cvt_pk_bf16_f32 v11, v82, v83
buffer_store_dwordx2 v[10:11], v8, s[24:27], s29 offen offset:0
s_nop 1
v_cvt_pk_bf16_f32 v10, v84, v85
v_cvt_pk_bf16_f32 v11, v86, v87
buffer_store_dwordx2 v[10:11], v8, s[24:27], s29 offen offset:16
s_nop 1
v_cvt_pk_bf16_f32 v10, v88, v89
v_cvt_pk_bf16_f32 v11, v90, v91
buffer_store_dwordx2 v[10:11], v8, s[24:27], s29 offen offset:32
s_nop 1
v_cvt_pk_bf16_f32 v10, v92, v93
v_cvt_pk_bf16_f32 v11, v94, v95
buffer_store_dwordx2 v[10:11], v8, s[24:27], s29 offen offset:48
s_nop 1
v_cvt_pk_bf16_f32 v10, v96, v97
v_cvt_pk_bf16_f32 v11, v98, v99
buffer_store_dwordx2 v[10:11], v8, s[24:27], s29 offen offset:64
s_nop 1
v_cvt_pk_bf16_f32 v10, v100, v101
v_cvt_pk_bf16_f32 v11, v102, v103
buffer_store_dwordx2 v[10:11], v8, s[24:27], s29 offen offset:80
s_nop 1
v_cvt_pk_bf16_f32 v10, v104, v105
v_cvt_pk_bf16_f32 v11, v106, v107
buffer_store_dwordx2 v[10:11], v8, s[24:27], s29 offen offset:96
s_nop 1
v_cvt_pk_bf16_f32 v10, v108, v109
v_cvt_pk_bf16_f32 v11, v110, v111
buffer_store_dwordx2 v[10:11], v8, s[24:27], s29 offen offset:112
s_nop 1
K1_END:
s_endpgm
.globl spmm_k2_kernel
.p2align 8
.type spmm_k2_kernel,@function
spmm_k2_kernel:
s_cmp_ge_u32 s2, 782
s_cbranch_scc1 K2_END
s_load_dwordx2 s[4:5], s[0:1], 40
s_load_dwordx2 s[6:7], s[0:1], 56
s_waitcnt lgkmcnt(0)
s_mov_b32 s8, s4
s_mov_b32 s9, s5
s_mov_b32 s10, 0x61a800
s_mov_b32 s11, 0x00020000
s_mov_b32 s12, s6
s_mov_b32 s13, s7
s_mov_b32 s14, 0x61a800
s_mov_b32 s15, 0x00020000
s_add_u32 s16, s6, 0x800000
s_addc_u32 s17, s7, 0
s_mov_b32 s18, 0x620000
s_mov_b32 s19, 0x00020000
s_add_u32 s20, s6, 0x1000000
s_addc_u32 s21, s7, 0
s_mov_b32 s22, 0xc4000
s_mov_b32 s23, 0x00020000
v_and_b32 v1, 63, v0
v_lshrrev_b32 v2, 6, v0
v_lshrrev_b32 v3, 3, v0
v_and_b32 v4, 7, v0
s_lshl_b32 s24, s2, 2
v_lshlrev_b32 v5, 12, v0
buffer_load_dwordx2 v[6:7], v5, s[20:23], s24 offen
v_readfirstlane_b32 s25, v2
s_waitcnt vmcnt(0)
v_sub_u32 v8, v7, v6
v_mov_b32 v9, v8
s_nop 1
v_add_u32_dpp v9, v9, v9 row_shr:1 row_mask:0xf bank_mask:0xf bound_ctrl:0
s_nop 1
v_add_u32_dpp v9, v9, v9 row_shr:2 row_mask:0xf bank_mask:0xf bound_ctrl:0
s_nop 1
v_add_u32_dpp v9, v9, v9 row_shr:4 row_mask:0xf bank_mask:0xf bound_ctrl:0
s_nop 1
v_add_u32_dpp v9, v9, v9 row_shr:8 row_mask:0xf bank_mask:0xf bound_ctrl:0
s_nop 1
v_add_u32_dpp v9, v9, v9 row_bcast:15 row_mask:0xa bank_mask:0xf
s_nop 1
v_add_u32_dpp v9, v9, v9 row_bcast:31 row_mask:0xc bank_mask:0xf
s_nop 1
v_lshlrev_b32 v10, 2, v2
v_cmp_eq_u32 vcc, 63, v1
s_and_saveexec_b64 s[26:27], vcc
ds_write_b32 v10, v9 offset:512
s_mov_b64 exec, s[26:27]
s_waitcnt lgkmcnt(0)
s_barrier
v_mov_b32 v10, 0
ds_read_b128 v[12:15], v10 offset:512
ds_read_b128 v[16:19], v10 offset:528
s_waitcnt lgkmcnt(0)
v_readfirstlane_b32 s28, v12
v_readfirstlane_b32 s29, v13
v_readfirstlane_b32 s30, v14
v_readfirstlane_b32 s31, v15
v_readfirstlane_b32 s32, v16
v_readfirstlane_b32 s33, v17
v_readfirstlane_b32 s34, v18
v_readfirstlane_b32 s35, v19
s_nop 4
s_mov_b32 s36, 0
s_mov_b32 s37, 0
s_cmp_gt_u32 s25, 0
s_cselect_b32 s38, s28, 0
s_add_u32 s36, s36, s38
s_add_u32 s37, s37, s28
s_cmp_gt_u32 s25, 1
s_cselect_b32 s38, s29, 0
s_add_u32 s36, s36, s38
s_add_u32 s37, s37, s29
s_cmp_gt_u32 s25, 2
s_cselect_b32 s38, s30, 0
s_add_u32 s36, s36, s38
s_add_u32 s37, s37, s30
s_cmp_gt_u32 s25, 3
s_cselect_b32 s38, s31, 0
s_add_u32 s36, s36, s38
s_add_u32 s37, s37, s31
s_cmp_gt_u32 s25, 4
s_cselect_b32 s38, s32, 0
s_add_u32 s36, s36, s38
s_add_u32 s37, s37, s32
s_cmp_gt_u32 s25, 5
s_cselect_b32 s38, s33, 0
s_add_u32 s36, s36, s38
s_add_u32 s37, s37, s33
s_cmp_gt_u32 s25, 6
s_cselect_b32 s38, s34, 0
s_add_u32 s36, s36, s38
s_add_u32 s37, s37, s34
s_cmp_gt_u32 s25, 7
s_cselect_b32 s38, s35, 0
s_add_u32 s36, s36, s38
s_add_u32 s37, s37, s35
v_sub_u32 v9, v9, v8
v_add_u32 v9, s36, v9
v_lshlrev_b32 v10, 12, v0
v_add_u32 v10, v10, v6
v_sub_u32 v10, v10, v9
v_lshlrev_b32 v11, 2, v0
v_cmp_gt_u32 vcc, 256, v0
s_and_saveexec_b64 s[26:27], vcc
ds_write_b32 v11, v9 offset:1024
ds_write_b32 v11, v10 offset:2048
s_mov_b64 exec, s[26:27]
v_mov_b32 v40, 0
v_mov_b32 v41, 0
v_mov_b32 v42, 0
v_mov_b32 v43, 0
v_mov_b32 v44, 0
v_mov_b32 v45, 0
v_mov_b32 v46, 0
v_mov_b32 v47, 0
s_mov_b32 s39, 0
K2_BATCH:
v_mov_b32 v12, 0
v_cmp_gt_u32 vcc, 64, v0
s_and_saveexec_b64 s[26:27], vcc
ds_write_b32 v11, v12 offset:0
s_mov_b64 exec, s[26:27]
s_sub_u32 s40, s37, s39
s_min_u32 s40, s40, 2048
s_waitcnt lgkmcnt(0)
s_barrier
s_mov_b32 s41, 0
K2_PB:
v_add_u32 v12, s41, v0
v_cmp_gt_u32 vcc, s40, v12
s_and_saveexec_b64 s[26:27], vcc
s_cbranch_execz K2_PB_SKIP
v_add_u32 v13, s39, v12
v_mov_b32 v14, 0
v_add_u32 v15, 128, v14
v_lshlrev_b32 v16, 2, v15
ds_read_b32 v16, v16 offset:1024
s_waitcnt lgkmcnt(0)
v_cmp_le_u32 vcc, v16, v13
s_nop 1
v_cndmask_b32 v14, v14, v15, vcc
v_add_u32 v15, 64, v14
v_lshlrev_b32 v16, 2, v15
ds_read_b32 v16, v16 offset:1024
s_waitcnt lgkmcnt(0)
v_cmp_le_u32 vcc, v16, v13
s_nop 1
v_cndmask_b32 v14, v14, v15, vcc
v_add_u32 v15, 32, v14
v_lshlrev_b32 v16, 2, v15
ds_read_b32 v16, v16 offset:1024
s_waitcnt lgkmcnt(0)
v_cmp_le_u32 vcc, v16, v13
s_nop 1
v_cndmask_b32 v14, v14, v15, vcc
v_add_u32 v15, 16, v14
v_lshlrev_b32 v16, 2, v15
ds_read_b32 v16, v16 offset:1024
s_waitcnt lgkmcnt(0)
v_cmp_le_u32 vcc, v16, v13
s_nop 1
v_cndmask_b32 v14, v14, v15, vcc
v_add_u32 v15, 8, v14
v_lshlrev_b32 v16, 2, v15
ds_read_b32 v16, v16 offset:1024
s_waitcnt lgkmcnt(0)
v_cmp_le_u32 vcc, v16, v13
s_nop 1
v_cndmask_b32 v14, v14, v15, vcc
v_add_u32 v15, 4, v14
v_lshlrev_b32 v16, 2, v15
ds_read_b32 v16, v16 offset:1024
s_waitcnt lgkmcnt(0)
v_cmp_le_u32 vcc, v16, v13
s_nop 1
v_cndmask_b32 v14, v14, v15, vcc
v_add_u32 v15, 2, v14
v_lshlrev_b32 v16, 2, v15
ds_read_b32 v16, v16 offset:1024
s_waitcnt lgkmcnt(0)
v_cmp_le_u32 vcc, v16, v13
s_nop 1
v_cndmask_b32 v14, v14, v15, vcc
v_add_u32 v15, 1, v14
v_lshlrev_b32 v16, 2, v15
ds_read_b32 v16, v16 offset:1024
s_waitcnt lgkmcnt(0)
v_cmp_le_u32 vcc, v16, v13
s_nop 1
v_cndmask_b32 v14, v14, v15, vcc
v_lshlrev_b32 v16, 2, v14
ds_read_b32 v16, v16 offset:2048
s_waitcnt lgkmcnt(0)
v_add_u32 v16, v16, v13
v_lshlrev_b32 v16, 3, v16
buffer_load_dwordx2 v[18:19], v16, s[16:19], 0 offen
v_mov_b32 v20, 1
s_waitcnt vmcnt(0)
v_lshlrev_b32 v21, 2, v19
ds_add_rtn_u32 v22, v21, v20 offset:0
s_waitcnt lgkmcnt(0)
v_lshl_or_b32 v19, v22, 6, v19
v_lshlrev_b32 v21, 3, v12
ds_write_b64 v21, v[18:19] offset:4096
K2_PB_SKIP:
s_mov_b64 exec, s[26:27]
s_add_u32 s41, s41, 512
s_cmp_lt_u32 s41, s40
s_cbranch_scc1 K2_PB
s_waitcnt lgkmcnt(0)
s_barrier
s_cmp_lg_u32 s25, 0
s_cbranch_scc1 K2_SCAN_DONE
v_lshlrev_b32 v12, 2, v1
ds_read_b32 v13, v12 offset:0
s_waitcnt lgkmcnt(0)
v_mov_b32 v14, v13
s_nop 1
v_add_u32_dpp v14, v14, v14 row_shr:1 row_mask:0xf bank_mask:0xf bound_ctrl:0
s_nop 1
v_add_u32_dpp v14, v14, v14 row_shr:2 row_mask:0xf bank_mask:0xf bound_ctrl:0
s_nop 1
v_add_u32_dpp v14, v14, v14 row_shr:4 row_mask:0xf bank_mask:0xf bound_ctrl:0
s_nop 1
v_add_u32_dpp v14, v14, v14 row_shr:8 row_mask:0xf bank_mask:0xf bound_ctrl:0
s_nop 1
v_add_u32_dpp v14, v14, v14 row_bcast:15 row_mask:0xa bank_mask:0xf
s_nop 1
v_add_u32_dpp v14, v14, v14 row_bcast:31 row_mask:0xc bank_mask:0xf
s_nop 1
v_sub_u32 v14, v14, v13
ds_write_b32 v12, v14 offset:256
s_waitcnt lgkmcnt(0)
K2_SCAN_DONE:
s_barrier
s_mov_b32 s41, 0
K2_PC:
v_add_u32 v12, s41, v0
v_cmp_gt_u32 vcc, s40, v12
s_and_saveexec_b64 s[26:27], vcc
s_cbranch_execz K2_PC_SKIP
v_lshlrev_b32 v13, 3, v12
ds_read_b64 v[14:15], v13 offset:4096
s_waitcnt lgkmcnt(0)
v_and_b32 v16, 63, v15
v_lshlrev_b32 v16, 2, v16
ds_read_b32 v16, v16 offset:256
v_lshrrev_b32 v15, 6, v15
s_waitcnt lgkmcnt(0)
v_add_u32 v16, v16, v15
v_lshlrev_b32 v16, 2, v16
ds_write_b32 v16, v14 offset:20480
K2_PC_SKIP:
s_mov_b64 exec, s[26:27]
s_add_u32 s41, s41, 512
s_cmp_lt_u32 s41, s40
s_cbranch_scc1 K2_PC
s_waitcnt lgkmcnt(0)
s_barrier
v_lshlrev_b32 v12, 2, v3
ds_read_b32 v13, v12 offset:256
ds_read_b32 v14, v12 offset:0
v_lshlrev_b32 v15, 4, v4
v_mov_b32 v16, 0
s_mov_b32 s42, 0xffff0000
v_mov_b32 v17, 0x7ffffff0
s_waitcnt lgkmcnt(0)
v_lshlrev_b32 v13, 2, v13
K2_PD:
v_add_u32 v18, 0, v16
v_lshl_add_u32 v19, v18, 2, v13
ds_read_b32 v24, v19 offset:20480
v_add_u32 v18, 1, v16
v_lshl_add_u32 v19, v18, 2, v13
ds_read_b32 v25, v19 offset:20480
v_add_u32 v18, 2, v16
v_lshl_add_u32 v19, v18, 2, v13
ds_read_b32 v26, v19 offset:20480
v_add_u32 v18, 3, v16
v_lshl_add_u32 v19, v18, 2, v13
ds_read_b32 v27, v19 offset:20480
s_waitcnt lgkmcnt(0)
v_add_u32 v18, 0, v16
v_cmp_lt_u32 vcc, v18, v14
v_and_b32 v19, 0xffff, v24
v_lshl_add_u32 v19, v19, 7, v15
v_cndmask_b32 v19, v17, v19, vcc
v_and_b32 v24, s42, v24
v_cndmask_b32 v24, 0, v24, vcc
buffer_load_dwordx4 v[48:51], v19, s[12:15], 0 offen
v_add_u32 v18, 1, v16
v_cmp_lt_u32 vcc, v18, v14
v_and_b32 v19, 0xffff, v25
v_lshl_add_u32 v19, v19, 7, v15
v_cndmask_b32 v19, v17, v19, vcc
v_and_b32 v25, s42, v25
v_cndmask_b32 v25, 0, v25, vcc
buffer_load_dwordx4 v[52:55], v19, s[12:15], 0 offen
v_add_u32 v18, 2, v16
v_cmp_lt_u32 vcc, v18, v14
v_and_b32 v19, 0xffff, v26
v_lshl_add_u32 v19, v19, 7, v15
v_cndmask_b32 v19, v17, v19, vcc
v_and_b32 v26, s42, v26
v_cndmask_b32 v26, 0, v26, vcc
buffer_load_dwordx4 v[56:59], v19, s[12:15], 0 offen
v_add_u32 v18, 3, v16
v_cmp_lt_u32 vcc, v18, v14
v_and_b32 v19, 0xffff, v27
v_lshl_add_u32 v19, v19, 7, v15
v_cndmask_b32 v19, v17, v19, vcc
v_and_b32 v27, s42, v27
v_cndmask_b32 v27, 0, v27, vcc
buffer_load_dwordx4 v[60:63], v19, s[12:15], 0 offen
s_waitcnt vmcnt(3)
v_lshlrev_b32 v20, 16, v48
v_and_b32 v21, s42, v48
v_fmac_f32 v40, v20, v24
v_fmac_f32 v41, v21, v24
v_lshlrev_b32 v20, 16, v49
v_and_b32 v21, s42, v49
v_fmac_f32 v42, v20, v24
v_fmac_f32 v43, v21, v24
v_lshlrev_b32 v20, 16, v50
v_and_b32 v21, s42, v50
v_fmac_f32 v44, v20, v24
v_fmac_f32 v45, v21, v24
v_lshlrev_b32 v20, 16, v51
v_and_b32 v21, s42, v51
v_fmac_f32 v46, v20, v24
v_fmac_f32 v47, v21, v24
s_waitcnt vmcnt(2)
v_lshlrev_b32 v20, 16, v52
v_and_b32 v21, s42, v52
v_fmac_f32 v40, v20, v25
v_fmac_f32 v41, v21, v25
v_lshlrev_b32 v20, 16, v53
v_and_b32 v21, s42, v53
v_fmac_f32 v42, v20, v25
v_fmac_f32 v43, v21, v25
v_lshlrev_b32 v20, 16, v54
v_and_b32 v21, s42, v54
v_fmac_f32 v44, v20, v25
v_fmac_f32 v45, v21, v25
v_lshlrev_b32 v20, 16, v55
v_and_b32 v21, s42, v55
v_fmac_f32 v46, v20, v25
v_fmac_f32 v47, v21, v25
s_waitcnt vmcnt(1)
v_lshlrev_b32 v20, 16, v56
v_and_b32 v21, s42, v56
v_fmac_f32 v40, v20, v26
v_fmac_f32 v41, v21, v26
v_lshlrev_b32 v20, 16, v57
v_and_b32 v21, s42, v57
v_fmac_f32 v42, v20, v26
v_fmac_f32 v43, v21, v26
v_lshlrev_b32 v20, 16, v58
v_and_b32 v21, s42, v58
v_fmac_f32 v44, v20, v26
v_fmac_f32 v45, v21, v26
v_lshlrev_b32 v20, 16, v59
v_and_b32 v21, s42, v59
v_fmac_f32 v46, v20, v26
v_fmac_f32 v47, v21, v26
s_waitcnt vmcnt(0)
v_lshlrev_b32 v20, 16, v60
v_and_b32 v21, s42, v60
v_fmac_f32 v40, v20, v27
v_fmac_f32 v41, v21, v27
v_lshlrev_b32 v20, 16, v61
v_and_b32 v21, s42, v61
v_fmac_f32 v42, v20, v27
v_fmac_f32 v43, v21, v27
v_lshlrev_b32 v20, 16, v62
v_and_b32 v21, s42, v62
v_fmac_f32 v44, v20, v27
v_fmac_f32 v45, v21, v27
v_lshlrev_b32 v20, 16, v63
v_and_b32 v21, s42, v63
v_fmac_f32 v46, v20, v27
v_fmac_f32 v47, v21, v27
v_add_u32 v16, 4, v16
v_cmp_lt_u32 vcc, v16, v14
s_nop 4
s_cbranch_vccnz K2_PD
s_add_u32 s39, s39, 2048
s_cmp_lt_u32 s39, s37
s_cbranch_scc0 K2_OUT
s_barrier
s_branch K2_BATCH
K2_OUT:
v_cvt_pk_bf16_f32 v20, v40, v41
v_cvt_pk_bf16_f32 v21, v42, v43
v_cvt_pk_bf16_f32 v22, v44, v45
v_cvt_pk_bf16_f32 v23, v46, v47
s_lshl_b32 s43, s2, 13
v_lshlrev_b32 v12, 4, v0
buffer_store_dwordx4 v[20:23], v12, s[8:11], s43 offen
K2_END:
s_endpgm
.section .rodata,"a"
.p2align 6
.amdhsa_kernel spmm_k1_kernel
  .amdhsa_next_free_vgpr 112
  .amdhsa_next_free_sgpr 64
  .amdhsa_accum_offset 112
  .amdhsa_group_segment_fixed_size 0
  .amdhsa_kernarg_size 64
  .amdhsa_user_sgpr_count 2
  .amdhsa_user_sgpr_kernarg_segment_ptr 1
  .amdhsa_system_sgpr_workgroup_id_x 1
.end_amdhsa_kernel
.section .rodata,"a"
.p2align 6
.amdhsa_kernel spmm_k2_kernel
  .amdhsa_next_free_vgpr 64
  .amdhsa_next_free_sgpr 64
  .amdhsa_accum_offset 64
  .amdhsa_group_segment_fixed_size 0
  .amdhsa_kernarg_size 64
  .amdhsa_user_sgpr_count 2
  .amdhsa_user_sgpr_kernarg_segment_ptr 1
  .amdhsa_system_sgpr_workgroup_id_x 1
.end_amdhsa_kernel
```

```asm
; @launch kernel=spmm_k1_kernel grid=(196,1,1) block=(256,1,1) lds=37120
; @launch kernel=spmm_k2_kernel grid=(782,1,1) block=(512,1,1) lds=44032
.amdgcn_target "amdgcn-amd-amdhsa--gfx950"
.text
.globl spmm_k1_kernel
.p2align 8
.type spmm_k1_kernel,@function
spmm_k1_kernel:
s_cmp_ge_u32 s2, 196
s_cbranch_scc1 K1_END
s_load_dwordx2 s[6:7], s[0:1], 8
s_load_dwordx4 s[8:11], s[0:1], 16
s_load_dwordx2 s[14:15], s[0:1], 56
s_waitcnt lgkmcnt(0)
s_mov_b32 s16, s8
s_mov_b32 s17, s9
s_mov_b32 s18, 0x30d400
s_mov_b32 s19, 0x00020000
s_mov_b32 s20, s6
s_mov_b32 s21, s7
s_mov_b32 s22, 0x30d400
s_mov_b32 s23, 0x00020000
s_mov_b32 s24, s10
s_mov_b32 s25, s11
s_mov_b32 s26, 0x186a00
s_mov_b32 s27, 0x00020000
s_add_u32 s28, s14, 0x800000
s_addc_u32 s29, s15, 0
s_mov_b32 s30, 0x620000
s_mov_b32 s31, 0x00020000
s_add_u32 s32, s14, 0x1000000
s_addc_u32 s33, s15, 0
s_mov_b32 s34, 0xc4000
s_mov_b32 s35, 0x00020000
s_mul_i32 s36, s2, 4096
v_lshlrev_b32 v1, 2, v0
v_add_u32 v1, s36, v1
v_lshlrev_b32 v2, 2, v1
v_lshlrev_b32 v3, 1, v1
v_mov_b32 v4, 0
v_mov_b32 v5, 0
v_mov_b32 v6, 0
v_mov_b32 v7, 0
v_lshlrev_b32 v8, 4, v0
ds_write_b128 v8, v[4:7] offset:0
s_mov_b32 s37, 4096
s_mov_b32 s45, 2048
s_mov_b32 s38, 8192
s_mov_b32 s46, 4096
s_mov_b32 s39, 12288
s_mov_b32 s47, 6144
buffer_load_dwordx4 v[12:15], v2, s[16:19], 0 offen
buffer_load_dwordx4 v[16:19], v2, s[16:19], s37 offen
buffer_load_dwordx4 v[20:23], v2, s[16:19], s38 offen
buffer_load_dwordx4 v[24:27], v2, s[16:19], s39 offen
buffer_load_dwordx4 v[28:31], v2, s[20:23], 0 offen
buffer_load_dwordx4 v[32:35], v2, s[20:23], s37 offen
buffer_load_dwordx4 v[36:39], v2, s[20:23], s38 offen
buffer_load_dwordx4 v[40:43], v2, s[20:23], s39 offen
buffer_load_dwordx2 v[44:45], v3, s[24:27], 0 offen
buffer_load_dwordx2 v[46:47], v3, s[24:27], s45 offen
buffer_load_dwordx2 v[48:49], v3, s[24:27], s46 offen
buffer_load_dwordx2 v[50:51], v3, s[24:27], s47 offen
s_mov_b32 s52, 0xffff0000
v_mov_b32 v9, 1
v_mov_b32 v10, 1023
s_waitcnt lgkmcnt(0)
s_barrier
s_waitcnt vmcnt(0)
v_add_u32 v11, 0, v1
v_cmp_gt_u32 vcc, 800000, v11
v_lshrrev_b32 v52, 6, v12
v_and_b32 v12, 63, v12
v_cndmask_b32 v52, v10, v52, vcc
v_lshlrev_b32 v52, 2, v52
v_lshl_or_b32 v28, v44, 16, v28
ds_add_rtn_u32 v68, v52, v9 offset:0
v_lshrrev_b32 v53, 6, v13
v_and_b32 v13, 63, v13
v_cndmask_b32 v53, v10, v53, vcc
v_lshlrev_b32 v53, 2, v53
v_and_or_b32 v29, v44, s52, v29
ds_add_rtn_u32 v69, v53, v9 offset:0
v_lshrrev_b32 v54, 6, v14
v_and_b32 v14, 63, v14
v_cndmask_b32 v54, v10, v54, vcc
v_lshlrev_b32 v54, 2, v54
v_lshl_or_b32 v30, v45, 16, v30
ds_add_rtn_u32 v70, v54, v9 offset:0
v_lshrrev_b32 v55, 6, v15
v_and_b32 v15, 63, v15
v_cndmask_b32 v55, v10, v55, vcc
v_lshlrev_b32 v55, 2, v55
v_and_or_b32 v31, v45, s52, v31
ds_add_rtn_u32 v71, v55, v9 offset:0
v_add_u32 v11, 1024, v1
v_cmp_gt_u32 vcc, 800000, v11
v_lshrrev_b32 v56, 6, v16
v_and_b32 v16, 63, v16
v_cndmask_b32 v56, v10, v56, vcc
v_lshlrev_b32 v56, 2, v56
v_lshl_or_b32 v32, v46, 16, v32
ds_add_rtn_u32 v72, v56, v9 offset:0
v_lshrrev_b32 v57, 6, v17
v_and_b32 v17, 63, v17
v_cndmask_b32 v57, v10, v57, vcc
v_lshlrev_b32 v57, 2, v57
v_and_or_b32 v33, v46, s52, v33
ds_add_rtn_u32 v73, v57, v9 offset:0
v_lshrrev_b32 v58, 6, v18
v_and_b32 v18, 63, v18
v_cndmask_b32 v58, v10, v58, vcc
v_lshlrev_b32 v58, 2, v58
v_lshl_or_b32 v34, v47, 16, v34
ds_add_rtn_u32 v74, v58, v9 offset:0
v_lshrrev_b32 v59, 6, v19
v_and_b32 v19, 63, v19
v_cndmask_b32 v59, v10, v59, vcc
v_lshlrev_b32 v59, 2, v59
v_and_or_b32 v35, v47, s52, v35
ds_add_rtn_u32 v75, v59, v9 offset:0
v_add_u32 v11, 2048, v1
v_cmp_gt_u32 vcc, 800000, v11
v_lshrrev_b32 v60, 6, v20
v_and_b32 v20, 63, v20
v_cndmask_b32 v60, v10, v60, vcc
v_lshlrev_b32 v60, 2, v60
v_lshl_or_b32 v36, v48, 16, v36
ds_add_rtn_u32 v76, v60, v9 offset:0
v_lshrrev_b32 v61, 6, v21
v_and_b32 v21, 63, v21
v_cndmask_b32 v61, v10, v61, vcc
v_lshlrev_b32 v61, 2, v61
v_and_or_b32 v37, v48, s52, v37
ds_add_rtn_u32 v77, v61, v9 offset:0
v_lshrrev_b32 v62, 6, v22
v_and_b32 v22, 63, v22
v_cndmask_b32 v62, v10, v62, vcc
v_lshlrev_b32 v62, 2, v62
v_lshl_or_b32 v38, v49, 16, v38
ds_add_rtn_u32 v78, v62, v9 offset:0
v_lshrrev_b32 v63, 6, v23
v_and_b32 v23, 63, v23
v_cndmask_b32 v63, v10, v63, vcc
v_lshlrev_b32 v63, 2, v63
v_and_or_b32 v39, v49, s52, v39
ds_add_rtn_u32 v79, v63, v9 offset:0
v_add_u32 v11, 3072, v1
v_cmp_gt_u32 vcc, 800000, v11
v_lshrrev_b32 v64, 6, v24
v_and_b32 v24, 63, v24
v_cndmask_b32 v64, v10, v64, vcc
v_lshlrev_b32 v64, 2, v64
v_lshl_or_b32 v40, v50, 16, v40
ds_add_rtn_u32 v80, v64, v9 offset:0
v_lshrrev_b32 v65, 6, v25
v_and_b32 v25, 63, v25
v_cndmask_b32 v65, v10, v65, vcc
v_lshlrev_b32 v65, 2, v65
v_and_or_b32 v41, v50, s52, v41
ds_add_rtn_u32 v81, v65, v9 offset:0
v_lshrrev_b32 v66, 6, v26
v_and_b32 v26, 63, v26
v_cndmask_b32 v66, v10, v66, vcc
v_lshlrev_b32 v66, 2, v66
v_lshl_or_b32 v42, v51, 16, v42
ds_add_rtn_u32 v82, v66, v9 offset:0
v_lshrrev_b32 v67, 6, v27
v_and_b32 v27, 63, v27
v_cndmask_b32 v67, v10, v67, vcc
v_lshlrev_b32 v67, 2, v67
v_and_or_b32 v43, v51, s52, v43
ds_add_rtn_u32 v83, v67, v9 offset:0
s_waitcnt lgkmcnt(0)
s_barrier
ds_read_b128 v[4:7], v8 offset:0
s_waitcnt lgkmcnt(0)
v_add_u32 v11, v4, v5
v_add_u32 v11, v11, v6
v_add_u32 v11, v11, v7
v_mov_b32 v84, v11
s_nop 1
v_add_u32_dpp v84, v84, v84 row_shr:1 row_mask:0xf bank_mask:0xf bound_ctrl:0
s_nop 1
v_add_u32_dpp v84, v84, v84 row_shr:2 row_mask:0xf bank_mask:0xf bound_ctrl:0
s_nop 1
v_add_u32_dpp v84, v84, v84 row_shr:4 row_mask:0xf bank_mask:0xf bound_ctrl:0
s_nop 1
v_add_u32_dpp v84, v84, v84 row_shr:8 row_mask:0xf bank_mask:0xf bound_ctrl:0
s_nop 1
v_add_u32_dpp v84, v84, v84 row_bcast:15 row_mask:0xa bank_mask:0xf
s_nop 1
v_add_u32_dpp v84, v84, v84 row_bcast:31 row_mask:0xc bank_mask:0xf
s_nop 1
v_and_b32 v85, 63, v0
v_lshrrev_b32 v86, 6, v0
v_lshlrev_b32 v87, 2, v86
v_cmp_eq_u32 vcc, 63, v85
s_and_saveexec_b64 s[54:55], vcc
ds_write_b32 v87, v84 offset:4096
s_mov_b64 exec, s[54:55]
s_waitcnt lgkmcnt(0)
s_barrier
v_mov_b32 v88, 0
ds_read_b128 v[88:91], v88 offset:4096
v_readfirstlane_b32 s56, v86
s_waitcnt lgkmcnt(0)
v_sub_u32 v84, v84, v11
s_cmp_gt_u32 s56, 0
s_cselect_b32 s57, 1, 0
v_mul_lo_u32 v92, v88, s57
v_add_u32 v84, v84, v92
s_cmp_gt_u32 s56, 1
s_cselect_b32 s57, 1, 0
v_mul_lo_u32 v92, v89, s57
v_add_u32 v84, v84, v92
s_cmp_gt_u32 s56, 2
s_cselect_b32 s57, 1, 0
v_mul_lo_u32 v92, v90, s57
v_add_u32 v84, v84, v92
v_mov_b32 v92, v84
v_add_u32 v93, v92, v4
v_add_u32 v94, v93, v5
v_add_u32 v95, v94, v6
ds_write_b128 v8, v[92:95] offset:0
s_lshl_b32 s57, s2, 12
buffer_store_dwordx4 v[92:95], v8, s[32:35], s57 offen
s_waitcnt lgkmcnt(0)
s_barrier
ds_read_b32 v52, v52 offset:0
ds_read_b32 v53, v53 offset:0
ds_read_b32 v54, v54 offset:0
ds_read_b32 v55, v55 offset:0
ds_read_b32 v56, v56 offset:0
ds_read_b32 v57, v57 offset:0
ds_read_b32 v58, v58 offset:0
ds_read_b32 v59, v59 offset:0
ds_read_b32 v60, v60 offset:0
ds_read_b32 v61, v61 offset:0
ds_read_b32 v62, v62 offset:0
ds_read_b32 v63, v63 offset:0
ds_read_b32 v64, v64 offset:0
ds_read_b32 v65, v65 offset:0
ds_read_b32 v66, v66 offset:0
ds_read_b32 v67, v67 offset:0
s_waitcnt lgkmcnt(0)
v_add_u32 v52, v52, v68
v_lshlrev_b32 v52, 3, v52
v_add_u32 v52, 4352, v52
ds_write2_b32 v52, v28, v12 offset0:0 offset1:1
v_add_u32 v53, v53, v69
v_lshlrev_b32 v53, 3, v53
v_add_u32 v53, 4352, v53
ds_write2_b32 v53, v29, v13 offset0:0 offset1:1
v_add_u32 v54, v54, v70
v_lshlrev_b32 v54, 3, v54
v_add_u32 v54, 4352, v54
ds_write2_b32 v54, v30, v14 offset0:0 offset1:1
v_add_u32 v55, v55, v71
v_lshlrev_b32 v55, 3, v55
v_add_u32 v55, 4352, v55
ds_write2_b32 v55, v31, v15 offset0:0 offset1:1
v_add_u32 v56, v56, v72
v_lshlrev_b32 v56, 3, v56
v_add_u32 v56, 4352, v56
ds_write2_b32 v56, v32, v16 offset0:0 offset1:1
v_add_u32 v57, v57, v73
v_lshlrev_b32 v57, 3, v57
v_add_u32 v57, 4352, v57
ds_write2_b32 v57, v33, v17 offset0:0 offset1:1
v_add_u32 v58, v58, v74
v_lshlrev_b32 v58, 3, v58
v_add_u32 v58, 4352, v58
ds_write2_b32 v58, v34, v18 offset0:0 offset1:1
v_add_u32 v59, v59, v75
v_lshlrev_b32 v59, 3, v59
v_add_u32 v59, 4352, v59
ds_write2_b32 v59, v35, v19 offset0:0 offset1:1
v_add_u32 v60, v60, v76
v_lshlrev_b32 v60, 3, v60
v_add_u32 v60, 4352, v60
ds_write2_b32 v60, v36, v20 offset0:0 offset1:1
v_add_u32 v61, v61, v77
v_lshlrev_b32 v61, 3, v61
v_add_u32 v61, 4352, v61
ds_write2_b32 v61, v37, v21 offset0:0 offset1:1
v_add_u32 v62, v62, v78
v_lshlrev_b32 v62, 3, v62
v_add_u32 v62, 4352, v62
ds_write2_b32 v62, v38, v22 offset0:0 offset1:1
v_add_u32 v63, v63, v79
v_lshlrev_b32 v63, 3, v63
v_add_u32 v63, 4352, v63
ds_write2_b32 v63, v39, v23 offset0:0 offset1:1
v_add_u32 v64, v64, v80
v_lshlrev_b32 v64, 3, v64
v_add_u32 v64, 4352, v64
ds_write2_b32 v64, v40, v24 offset0:0 offset1:1
v_add_u32 v65, v65, v81
v_lshlrev_b32 v65, 3, v65
v_add_u32 v65, 4352, v65
ds_write2_b32 v65, v41, v25 offset0:0 offset1:1
v_add_u32 v66, v66, v82
v_lshlrev_b32 v66, 3, v66
v_add_u32 v66, 4352, v66
ds_write2_b32 v66, v42, v26 offset0:0 offset1:1
v_add_u32 v67, v67, v83
v_lshlrev_b32 v67, 3, v67
v_add_u32 v67, 4352, v67
ds_write2_b32 v67, v43, v27 offset0:0 offset1:1
s_waitcnt lgkmcnt(0)
s_barrier
s_mul_i32 s57, s2, 32768
ds_read_b128 v[12:15], v8 offset:4352
ds_read_b128 v[16:19], v8 offset:8448
ds_read_b128 v[20:23], v8 offset:12544
ds_read_b128 v[24:27], v8 offset:16640
ds_read_b128 v[28:31], v8 offset:20736
ds_read_b128 v[32:35], v8 offset:24832
ds_read_b128 v[36:39], v8 offset:28928
ds_read_b128 v[40:43], v8 offset:33024
s_waitcnt lgkmcnt(7)
buffer_store_dwordx4 v[12:15], v8, s[28:31], s57 offen
s_waitcnt lgkmcnt(6)
s_add_u32 s58, s57, 4096
buffer_store_dwordx4 v[16:19], v8, s[28:31], s58 offen
s_waitcnt lgkmcnt(5)
s_add_u32 s58, s57, 8192
buffer_store_dwordx4 v[20:23], v8, s[28:31], s58 offen
s_waitcnt lgkmcnt(4)
s_add_u32 s58, s57, 12288
buffer_store_dwordx4 v[24:27], v8, s[28:31], s58 offen
s_waitcnt lgkmcnt(3)
s_add_u32 s58, s57, 16384
buffer_store_dwordx4 v[28:31], v8, s[28:31], s58 offen
s_waitcnt lgkmcnt(2)
s_add_u32 s58, s57, 20480
buffer_store_dwordx4 v[32:35], v8, s[28:31], s58 offen
s_waitcnt lgkmcnt(1)
s_add_u32 s58, s57, 24576
buffer_store_dwordx4 v[36:39], v8, s[28:31], s58 offen
s_waitcnt lgkmcnt(0)
s_add_u32 s58, s57, 28672
buffer_store_dwordx4 v[40:43], v8, s[28:31], s58 offen
K1_END:
s_endpgm
.globl spmm_k2_kernel
.p2align 8
.type spmm_k2_kernel,@function
spmm_k2_kernel:
s_cmp_ge_u32 s2, 782
s_cbranch_scc1 K2_END
s_load_dwordx2 s[4:5], s[0:1], 40
s_load_dwordx2 s[6:7], s[0:1], 56
s_load_dwordx2 s[44:45], s[0:1], 0
s_load_dwordx2 s[46:47], s[0:1], 32
s_waitcnt lgkmcnt(0)
s_mov_b32 s8, s4
s_mov_b32 s9, s5
s_mov_b32 s10, 0x61a800
s_mov_b32 s11, 0x00020000
s_mov_b32 s12, s44
s_mov_b32 s13, s45
s_mov_b32 s14, 0x61a800
s_mov_b32 s15, 0x00020000
s_add_u32 s16, s6, 0x800000
s_addc_u32 s17, s7, 0
s_mov_b32 s18, 0x620000
s_mov_b32 s19, 0x00020000
s_add_u32 s20, s6, 0x1000000
s_addc_u32 s21, s7, 0
s_mov_b32 s22, 0xc4000
s_mov_b32 s23, 0x00020000
s_mov_b32 s48, s46
s_mov_b32 s49, s47
s_mov_b32 s50, 0x2000
s_mov_b32 s51, 0x00020000
v_and_b32 v1, 63, v0
v_lshrrev_b32 v2, 6, v0
v_lshrrev_b32 v3, 3, v0
v_and_b32 v4, 7, v0
s_lshl_b32 s24, s2, 2
v_lshlrev_b32 v5, 12, v0
buffer_load_dwordx2 v[6:7], v5, s[20:23], s24 offen
v_lshlrev_b32 v12, 4, v0
buffer_load_dwordx4 v[16:19], v12, s[48:51], 0 offen
v_readfirstlane_b32 s25, v2
v_mov_b32 v13, 0
v_lshlrev_b32 v11, 2, v0
v_cmp_gt_u32 vcc, 64, v0
s_and_saveexec_b64 s[26:27], vcc
ds_write_b32 v11, v13 offset:0
s_mov_b64 exec, s[26:27]
s_waitcnt vmcnt(1)
v_sub_u32 v8, v7, v6
v_mov_b32 v9, v8
s_nop 1
v_add_u32_dpp v9, v9, v9 row_shr:1 row_mask:0xf bank_mask:0xf bound_ctrl:0
s_nop 1
v_add_u32_dpp v9, v9, v9 row_shr:2 row_mask:0xf bank_mask:0xf bound_ctrl:0
s_nop 1
v_add_u32_dpp v9, v9, v9 row_shr:4 row_mask:0xf bank_mask:0xf bound_ctrl:0
s_nop 1
v_add_u32_dpp v9, v9, v9 row_shr:8 row_mask:0xf bank_mask:0xf bound_ctrl:0
s_nop 1
v_add_u32_dpp v9, v9, v9 row_bcast:15 row_mask:0xa bank_mask:0xf
s_nop 1
v_add_u32_dpp v9, v9, v9 row_bcast:31 row_mask:0xc bank_mask:0xf
s_nop 1
v_lshlrev_b32 v10, 2, v2
v_cmp_eq_u32 vcc, 63, v1
s_and_saveexec_b64 s[26:27], vcc
ds_write_b32 v10, v9 offset:512
s_mov_b64 exec, s[26:27]
s_waitcnt vmcnt(0)
v_lshlrev_b32 v20, 16, v16
v_and_b32 v21, 0xffff0000, v16
v_lshlrev_b32 v22, 16, v17
v_and_b32 v23, 0xffff0000, v17
v_lshlrev_b32 v24, 16, v18
v_and_b32 v25, 0xffff0000, v18
v_lshlrev_b32 v26, 16, v19
v_and_b32 v27, 0xffff0000, v19
v_lshlrev_b32 v12, 5, v0
ds_write_b128 v12, v[20:23] offset:27648
ds_write_b128 v12, v[24:27] offset:27664
s_waitcnt lgkmcnt(0)
s_barrier
v_mov_b32 v10, 0
ds_read_b128 v[12:15], v10 offset:512
ds_read_b128 v[16:19], v10 offset:528
s_waitcnt lgkmcnt(0)
v_readfirstlane_b32 s28, v12
v_readfirstlane_b32 s29, v13
v_readfirstlane_b32 s30, v14
v_readfirstlane_b32 s31, v15
v_readfirstlane_b32 s32, v16
v_readfirstlane_b32 s33, v17
v_readfirstlane_b32 s34, v18
v_readfirstlane_b32 s35, v19
s_nop 4
s_mov_b32 s36, 0
s_mov_b32 s37, 0
s_cmp_gt_u32 s25, 0
s_cselect_b32 s38, s28, 0
s_add_u32 s36, s36, s38
s_add_u32 s37, s37, s28
s_cmp_gt_u32 s25, 1
s_cselect_b32 s38, s29, 0
s_add_u32 s36, s36, s38
s_add_u32 s37, s37, s29
s_cmp_gt_u32 s25, 2
s_cselect_b32 s38, s30, 0
s_add_u32 s36, s36, s38
s_add_u32 s37, s37, s30
s_cmp_gt_u32 s25, 3
s_cselect_b32 s38, s31, 0
s_add_u32 s36, s36, s38
s_add_u32 s37, s37, s31
s_cmp_gt_u32 s25, 4
s_cselect_b32 s38, s32, 0
s_add_u32 s36, s36, s38
s_add_u32 s37, s37, s32
s_cmp_gt_u32 s25, 5
s_cselect_b32 s38, s33, 0
s_add_u32 s36, s36, s38
s_add_u32 s37, s37, s33
s_cmp_gt_u32 s25, 6
s_cselect_b32 s38, s34, 0
s_add_u32 s36, s36, s38
s_add_u32 s37, s37, s34
s_cmp_gt_u32 s25, 7
s_cselect_b32 s38, s35, 0
s_add_u32 s36, s36, s38
s_add_u32 s37, s37, s35
v_sub_u32 v9, v9, v8
v_add_u32 v9, s36, v9
v_mul_u32_u24 v10, 4096, v0
v_add_u32 v10, v10, v6
v_sub_u32 v10, v10, v9
v_cmp_gt_u32 vcc, 256, v0
s_and_saveexec_b64 s[26:27], vcc
ds_write_b32 v11, v9 offset:1024
ds_write_b32 v11, v10 offset:2048
s_mov_b64 exec, s[26:27]
v_mov_b32 v40, 0
v_mov_b32 v41, 0
v_mov_b32 v42, 0
v_mov_b32 v43, 0
v_mov_b32 v44, 0
v_mov_b32 v45, 0
v_mov_b32 v46, 0
v_mov_b32 v47, 0
s_mov_b32 s39, 0
s_mov_b32 s42, 0xffff0000
K2_BATCH:
s_sub_u32 s40, s37, s39
s_min_u32 s40, s40, 2048
s_waitcnt lgkmcnt(0)
s_barrier
s_mov_b32 s41, 0
K2_PB:
v_add_u32 v12, s41, v0
v_add_u32 v13, 512, v12
v_add_u32 v14, s39, v12
v_add_u32 v15, s39, v13
v_mov_b32 v16, 0
v_mov_b32 v17, 0
v_add_u32 v18, 128, v16
v_add_u32 v19, 128, v17
v_lshlrev_b32 v20, 2, v18
v_lshlrev_b32 v21, 2, v19
ds_read_b32 v20, v20 offset:1024
ds_read_b32 v21, v21 offset:1024
s_waitcnt lgkmcnt(1)
v_cmp_le_u32 vcc, v20, v14
s_waitcnt lgkmcnt(0)
v_cmp_le_u32 s[52:53], v21, v15
s_nop 1
v_cndmask_b32 v16, v16, v18, vcc
v_cndmask_b32 v17, v17, v19, s[52:53]
v_add_u32 v18, 64, v16
v_add_u32 v19, 64, v17
v_lshlrev_b32 v20, 2, v18
v_lshlrev_b32 v21, 2, v19
ds_read_b32 v20, v20 offset:1024
ds_read_b32 v21, v21 offset:1024
s_waitcnt lgkmcnt(1)
v_cmp_le_u32 vcc, v20, v14
s_waitcnt lgkmcnt(0)
v_cmp_le_u32 s[52:53], v21, v15
s_nop 1
v_cndmask_b32 v16, v16, v18, vcc
v_cndmask_b32 v17, v17, v19, s[52:53]
v_add_u32 v18, 32, v16
v_add_u32 v19, 32, v17
v_lshlrev_b32 v20, 2, v18
v_lshlrev_b32 v21, 2, v19
ds_read_b32 v20, v20 offset:1024
ds_read_b32 v21, v21 offset:1024
s_waitcnt lgkmcnt(1)
v_cmp_le_u32 vcc, v20, v14
s_waitcnt lgkmcnt(0)
v_cmp_le_u32 s[52:53], v21, v15
s_nop 1
v_cndmask_b32 v16, v16, v18, vcc
v_cndmask_b32 v17, v17, v19, s[52:53]
v_add_u32 v18, 16, v16
v_add_u32 v19, 16, v17
v_lshlrev_b32 v20, 2, v18
v_lshlrev_b32 v21, 2, v19
ds_read_b32 v20, v20 offset:1024
ds_read_b32 v21, v21 offset:1024
s_waitcnt lgkmcnt(1)
v_cmp_le_u32 vcc, v20, v14
s_waitcnt lgkmcnt(0)
v_cmp_le_u32 s[52:53], v21, v15
s_nop 1
v_cndmask_b32 v16, v16, v18, vcc
v_cndmask_b32 v17, v17, v19, s[52:53]
v_add_u32 v18, 8, v16
v_add_u32 v19, 8, v17
v_lshlrev_b32 v20, 2, v18
v_lshlrev_b32 v21, 2, v19
ds_read_b32 v20, v20 offset:1024
ds_read_b32 v21, v21 offset:1024
s_waitcnt lgkmcnt(1)
v_cmp_le_u32 vcc, v20, v14
s_waitcnt lgkmcnt(0)
v_cmp_le_u32 s[52:53], v21, v15
s_nop 1
v_cndmask_b32 v16, v16, v18, vcc
v_cndmask_b32 v17, v17, v19, s[52:53]
v_add_u32 v18, 4, v16
v_add_u32 v19, 4, v17
v_lshlrev_b32 v20, 2, v18
v_lshlrev_b32 v21, 2, v19
ds_read_b32 v20, v20 offset:1024
ds_read_b32 v21, v21 offset:1024
s_waitcnt lgkmcnt(1)
v_cmp_le_u32 vcc, v20, v14
s_waitcnt lgkmcnt(0)
v_cmp_le_u32 s[52:53], v21, v15
s_nop 1
v_cndmask_b32 v16, v16, v18, vcc
v_cndmask_b32 v17, v17, v19, s[52:53]
v_add_u32 v18, 2, v16
v_add_u32 v19, 2, v17
v_lshlrev_b32 v20, 2, v18
v_lshlrev_b32 v21, 2, v19
ds_read_b32 v20, v20 offset:1024
ds_read_b32 v21, v21 offset:1024
s_waitcnt lgkmcnt(1)
v_cmp_le_u32 vcc, v20, v14
s_waitcnt lgkmcnt(0)
v_cmp_le_u32 s[52:53], v21, v15
s_nop 1
v_cndmask_b32 v16, v16, v18, vcc
v_cndmask_b32 v17, v17, v19, s[52:53]
v_add_u32 v18, 1, v16
v_add_u32 v19, 1, v17
v_lshlrev_b32 v20, 2, v18
v_lshlrev_b32 v21, 2, v19
ds_read_b32 v20, v20 offset:1024
ds_read_b32 v21, v21 offset:1024
s_waitcnt lgkmcnt(1)
v_cmp_le_u32 vcc, v20, v14
s_waitcnt lgkmcnt(0)
v_cmp_le_u32 s[52:53], v21, v15
s_nop 1
v_cndmask_b32 v16, v16, v18, vcc
v_cndmask_b32 v17, v17, v19, s[52:53]
v_lshlrev_b32 v20, 2, v16
v_lshlrev_b32 v21, 2, v17
ds_read_b32 v20, v20 offset:2048
ds_read_b32 v21, v21 offset:2048
v_cmp_gt_u32 s[52:53], s40, v12
v_cmp_gt_u32 s[54:55], s40, v13
v_mov_b32 v22, 0x7ffffff0
s_waitcnt lgkmcnt(0)
v_add_u32 v20, v20, v14
v_add_u32 v21, v21, v15
v_lshlrev_b32 v20, 3, v20
v_lshlrev_b32 v21, 3, v21
v_cndmask_b32 v20, v22, v20, s[52:53]
v_cndmask_b32 v21, v22, v21, s[54:55]
buffer_load_dwordx2 v[24:25], v20, s[16:19], 0 offen
buffer_load_dwordx2 v[26:27], v21, s[16:19], 0 offen
v_mov_b32 v23, 1
s_mov_b64 s[56:57], exec
s_waitcnt vmcnt(1)
v_lshlrev_b32 v28, 2, v25
s_mov_b64 exec, s[52:53]
ds_add_rtn_u32 v30, v28, v23 offset:0
s_mov_b64 exec, s[56:57]
s_waitcnt vmcnt(0)
v_lshlrev_b32 v29, 2, v27
s_mov_b64 exec, s[54:55]
ds_add_rtn_u32 v31, v29, v23 offset:0
s_mov_b64 exec, s[56:57]
v_lshlrev_b32 v28, 3, v12
v_lshlrev_b32 v29, 3, v13
s_waitcnt lgkmcnt(0)
v_lshl_or_b32 v25, v30, 6, v25
v_lshl_or_b32 v27, v31, 6, v27
s_mov_b64 exec, s[52:53]
ds_write_b64 v28, v[24:25] offset:3072
s_mov_b64 exec, s[54:55]
ds_write_b64 v29, v[26:27] offset:3072
s_mov_b64 exec, s[56:57]
s_add_u32 s41, s41, 1024
s_cmp_lt_u32 s41, s40
s_cbranch_scc1 K2_PB
s_waitcnt lgkmcnt(0)
s_barrier
s_cmp_lg_u32 s25, 0
s_cbranch_scc1 K2_SCAN_DONE
v_lshlrev_b32 v12, 2, v1
ds_read_b32 v13, v12 offset:0
s_waitcnt lgkmcnt(0)
v_mov_b32 v14, v13
s_nop 1
v_add_u32_dpp v14, v14, v14 row_shr:1 row_mask:0xf bank_mask:0xf bound_ctrl:0
s_nop 1
v_add_u32_dpp v14, v14, v14 row_shr:2 row_mask:0xf bank_mask:0xf bound_ctrl:0
s_nop 1
v_add_u32_dpp v14, v14, v14 row_shr:4 row_mask:0xf bank_mask:0xf bound_ctrl:0
s_nop 1
v_add_u32_dpp v14, v14, v14 row_shr:8 row_mask:0xf bank_mask:0xf bound_ctrl:0
s_nop 1
v_add_u32_dpp v14, v14, v14 row_bcast:15 row_mask:0xa bank_mask:0xf
s_nop 1
v_add_u32_dpp v14, v14, v14 row_bcast:31 row_mask:0xc bank_mask:0xf
s_nop 1
v_sub_u32 v14, v14, v13
ds_write_b32 v12, v14 offset:256
s_waitcnt lgkmcnt(0)
K2_SCAN_DONE:
s_barrier
s_mov_b32 s41, 0
K2_PC:
v_add_u32 v12, s41, v0
v_add_u32 v13, 512, v12
v_cmp_gt_u32 s[52:53], s40, v12
v_cmp_gt_u32 s[54:55], s40, v13
v_lshlrev_b32 v14, 3, v12
v_lshlrev_b32 v15, 3, v13
ds_read_b64 v[16:17], v14 offset:3072
ds_read_b64 v[18:19], v15 offset:3072
s_waitcnt lgkmcnt(0)
v_and_b32 v20, 63, v17
v_and_b32 v21, 63, v19
v_lshlrev_b32 v20, 2, v20
v_lshlrev_b32 v21, 2, v21
ds_read_b32 v20, v20 offset:256
ds_read_b32 v21, v21 offset:256
v_lshrrev_b32 v17, 6, v17
v_lshrrev_b32 v19, 6, v19
s_waitcnt lgkmcnt(0)
v_add_u32 v20, v20, v17
v_add_u32 v21, v21, v19
v_lshlrev_b32 v20, 2, v20
v_lshlrev_b32 v21, 2, v21
s_mov_b64 exec, s[52:53]
ds_write_b32 v20, v16 offset:19456
s_mov_b64 exec, s[54:55]
ds_write_b32 v21, v18 offset:19456
s_mov_b64 exec, s[56:57]
s_add_u32 s41, s41, 1024
s_cmp_lt_u32 s41, s40
s_cbranch_scc1 K2_PC
s_waitcnt lgkmcnt(0)
s_barrier
v_lshlrev_b32 v12, 2, v3
ds_read_b32 v13, v12 offset:256
ds_read_b32 v14, v12 offset:0
v_lshlrev_b32 v15, 4, v4
v_mov_b32 v16, 0
v_mov_b32 v17, 0x7ffffff0
s_waitcnt lgkmcnt(0)
v_lshlrev_b32 v13, 2, v13
K2_PD:
v_add_u32 v18, 0, v16
v_lshl_add_u32 v19, v18, 2, v13
ds_read_b32 v24, v19 offset:19456
v_add_u32 v18, 1, v16
v_lshl_add_u32 v19, v18, 2, v13
ds_read_b32 v25, v19 offset:19456
v_add_u32 v18, 2, v16
v_lshl_add_u32 v19, v18, 2, v13
ds_read_b32 v26, v19 offset:19456
v_add_u32 v18, 3, v16
v_lshl_add_u32 v19, v18, 2, v13
ds_read_b32 v27, v19 offset:19456
s_waitcnt lgkmcnt(0)
v_add_u32 v18, 0, v16
v_cmp_lt_u32 vcc, v18, v14
v_and_b32 v19, 0xffff, v24
v_lshl_add_u32 v19, v19, 7, v15
v_cndmask_b32 v19, v17, v19, vcc
v_cndmask_b32 v24, 0, v24, vcc
buffer_load_dwordx4 v[48:51], v19, s[12:15], 0 offen
v_lshrrev_b32 v28, 16, v24
v_and_b32 v24, s42, v24
v_add_u32 v18, 1, v16
v_cmp_lt_u32 vcc, v18, v14
v_and_b32 v19, 0xffff, v25
v_lshl_add_u32 v19, v19, 7, v15
v_cndmask_b32 v19, v17, v19, vcc
v_cndmask_b32 v25, 0, v25, vcc
buffer_load_dwordx4 v[52:55], v19, s[12:15], 0 offen
v_lshrrev_b32 v29, 16, v25
v_and_b32 v25, s42, v25
v_add_u32 v18, 2, v16
v_cmp_lt_u32 vcc, v18, v14
v_and_b32 v19, 0xffff, v26
v_lshl_add_u32 v19, v19, 7, v15
v_cndmask_b32 v19, v17, v19, vcc
v_cndmask_b32 v26, 0, v26, vcc
buffer_load_dwordx4 v[56:59], v19, s[12:15], 0 offen
v_lshrrev_b32 v30, 16, v26
v_and_b32 v26, s42, v26
v_add_u32 v18, 3, v16
v_cmp_lt_u32 vcc, v18, v14
v_and_b32 v19, 0xffff, v27
v_lshl_add_u32 v19, v19, 7, v15
v_cndmask_b32 v19, v17, v19, vcc
v_cndmask_b32 v27, 0, v27, vcc
buffer_load_dwordx4 v[60:63], v19, s[12:15], 0 offen
v_lshrrev_b32 v31, 16, v27
v_and_b32 v27, s42, v27
s_waitcnt vmcnt(3)
v_dot2_f32_bf16 v40, v48, v28, v40
v_dot2_f32_bf16 v41, v48, v24, v41
v_dot2_f32_bf16 v42, v49, v28, v42
v_dot2_f32_bf16 v43, v49, v24, v43
v_dot2_f32_bf16 v44, v50, v28, v44
v_dot2_f32_bf16 v45, v50, v24, v45
v_dot2_f32_bf16 v46, v51, v28, v46
v_dot2_f32_bf16 v47, v51, v24, v47
s_waitcnt vmcnt(2)
v_dot2_f32_bf16 v40, v52, v29, v40
v_dot2_f32_bf16 v41, v52, v25, v41
v_dot2_f32_bf16 v42, v53, v29, v42
v_dot2_f32_bf16 v43, v53, v25, v43
v_dot2_f32_bf16 v44, v54, v29, v44
v_dot2_f32_bf16 v45, v54, v25, v45
v_dot2_f32_bf16 v46, v55, v29, v46
v_dot2_f32_bf16 v47, v55, v25, v47
s_waitcnt vmcnt(1)
v_dot2_f32_bf16 v40, v56, v30, v40
v_dot2_f32_bf16 v41, v56, v26, v41
v_dot2_f32_bf16 v42, v57, v30, v42
v_dot2_f32_bf16 v43, v57, v26, v43
v_dot2_f32_bf16 v44, v58, v30, v44
v_dot2_f32_bf16 v45, v58, v26, v45
v_dot2_f32_bf16 v46, v59, v30, v46
v_dot2_f32_bf16 v47, v59, v26, v47
s_waitcnt vmcnt(0)
v_dot2_f32_bf16 v40, v60, v31, v40
v_dot2_f32_bf16 v41, v60, v27, v41
v_dot2_f32_bf16 v42, v61, v31, v42
v_dot2_f32_bf16 v43, v61, v27, v43
v_dot2_f32_bf16 v44, v62, v31, v44
v_dot2_f32_bf16 v45, v62, v27, v45
v_dot2_f32_bf16 v46, v63, v31, v46
v_dot2_f32_bf16 v47, v63, v27, v47
v_add_u32 v16, 4, v16
v_cmp_lt_u32 vcc, v16, v14
s_nop 4
s_cbranch_vccnz K2_PD
K2_NOD:
s_add_u32 s39, s39, 2048
s_cmp_lt_u32 s39, s37
s_cbranch_scc0 K2_OUT
s_barrier
v_mov_b32 v13, 0
v_cmp_gt_u32 vcc, 64, v0
s_and_saveexec_b64 s[26:27], vcc
ds_write_b32 v11, v13 offset:0
s_mov_b64 exec, s[26:27]
s_branch K2_BATCH
K2_OUT:
s_barrier
v_mul_u32_u24 v12, 260, v3
v_lshl_add_u32 v12, v4, 5, v12
ds_write_b32 v12, v40 offset:3072
ds_write_b32 v12, v41 offset:3076
ds_write_b32 v12, v42 offset:3080
ds_write_b32 v12, v43 offset:3084
ds_write_b32 v12, v44 offset:3088
ds_write_b32 v12, v45 offset:3092
ds_write_b32 v12, v46 offset:3096
ds_write_b32 v12, v47 offset:3100
s_waitcnt lgkmcnt(0)
s_barrier
s_cmp_gt_u32 s25, 3
s_cbranch_scc1 K2_END
s_and_b32 s26, s25, 1
s_lshr_b32 s27, s25, 1
v_and_b32 v12, 31, v1
v_lshrrev_b32 v13, 5, v1
s_lshl_b32 s28, s26, 7
v_lshlrev_b32 v14, 8, v13
v_lshl_add_u32 v14, v12, 2, v14
v_add_u32 v14, s28, v14
s_lshl_b32 s29, s27, 5
v_add_u32 v15, s29, v12
v_mul_u32_u24 v15, 260, v15
v_lshl_add_u32 v15, v13, 2, v15
ds_read_b32 v32, v14 offset:27648
ds_read_b32 v33, v15 offset:3072
s_waitcnt lgkmcnt(0)
v_mfma_f32_32x32x2_f32 v[16:31], v32, v33, 0
ds_read_b32 v34, v14 offset:28160
ds_read_b32 v35, v15 offset:3080
s_waitcnt lgkmcnt(0)
v_mfma_f32_32x32x2_f32 v[16:31], v34, v35, v[16:31]
ds_read_b32 v36, v14 offset:28672
ds_read_b32 v37, v15 offset:3088
s_waitcnt lgkmcnt(0)
v_mfma_f32_32x32x2_f32 v[16:31], v36, v37, v[16:31]
ds_read_b32 v38, v14 offset:29184
ds_read_b32 v39, v15 offset:3096
s_waitcnt lgkmcnt(0)
v_mfma_f32_32x32x2_f32 v[16:31], v38, v39, v[16:31]
ds_read_b32 v32, v14 offset:29696
ds_read_b32 v33, v15 offset:3104
s_waitcnt lgkmcnt(0)
v_mfma_f32_32x32x2_f32 v[16:31], v32, v33, v[16:31]
ds_read_b32 v34, v14 offset:30208
ds_read_b32 v35, v15 offset:3112
s_waitcnt lgkmcnt(0)
v_mfma_f32_32x32x2_f32 v[16:31], v34, v35, v[16:31]
ds_read_b32 v36, v14 offset:30720
ds_read_b32 v37, v15 offset:3120
s_waitcnt lgkmcnt(0)
v_mfma_f32_32x32x2_f32 v[16:31], v36, v37, v[16:31]
ds_read_b32 v38, v14 offset:31232
ds_read_b32 v39, v15 offset:3128
s_waitcnt lgkmcnt(0)
v_mfma_f32_32x32x2_f32 v[16:31], v38, v39, v[16:31]
ds_read_b32 v32, v14 offset:31744
ds_read_b32 v33, v15 offset:3136
s_waitcnt lgkmcnt(0)
v_mfma_f32_32x32x2_f32 v[16:31], v32, v33, v[16:31]
ds_read_b32 v34, v14 offset:32256
ds_read_b32 v35, v15 offset:3144
s_waitcnt lgkmcnt(0)
v_mfma_f32_32x32x2_f32 v[16:31], v34, v35, v[16:31]
ds_read_b32 v36, v14 offset:32768
ds_read_b32 v37, v15 offset:3152
s_waitcnt lgkmcnt(0)
v_mfma_f32_32x32x2_f32 v[16:31], v36, v37, v[16:31]
ds_read_b32 v38, v14 offset:33280
ds_read_b32 v39, v15 offset:3160
s_waitcnt lgkmcnt(0)
v_mfma_f32_32x32x2_f32 v[16:31], v38, v39, v[16:31]
ds_read_b32 v32, v14 offset:33792
ds_read_b32 v33, v15 offset:3168
s_waitcnt lgkmcnt(0)
v_mfma_f32_32x32x2_f32 v[16:31], v32, v33, v[16:31]
ds_read_b32 v34, v14 offset:34304
ds_read_b32 v35, v15 offset:3176
s_waitcnt lgkmcnt(0)
v_mfma_f32_32x32x2_f32 v[16:31], v34, v35, v[16:31]
ds_read_b32 v36, v14 offset:34816
ds_read_b32 v37, v15 offset:3184
s_waitcnt lgkmcnt(0)
v_mfma_f32_32x32x2_f32 v[16:31], v36, v37, v[16:31]
ds_read_b32 v38, v14 offset:35328
ds_read_b32 v39, v15 offset:3192
s_waitcnt lgkmcnt(0)
v_mfma_f32_32x32x2_f32 v[16:31], v38, v39, v[16:31]
ds_read_b32 v32, v14 offset:35840
ds_read_b32 v33, v15 offset:3200
s_waitcnt lgkmcnt(0)
v_mfma_f32_32x32x2_f32 v[16:31], v32, v33, v[16:31]
ds_read_b32 v34, v14 offset:36352
ds_read_b32 v35, v15 offset:3208
s_waitcnt lgkmcnt(0)
v_mfma_f32_32x32x2_f32 v[16:31], v34, v35, v[16:31]
ds_read_b32 v36, v14 offset:36864
ds_read_b32 v37, v15 offset:3216
s_waitcnt lgkmcnt(0)
v_mfma_f32_32x32x2_f32 v[16:31], v36, v37, v[16:31]
ds_read_b32 v38, v14 offset:37376
ds_read_b32 v39, v15 offset:3224
s_waitcnt lgkmcnt(0)
v_mfma_f32_32x32x2_f32 v[16:31], v38, v39, v[16:31]
ds_read_b32 v32, v14 offset:37888
ds_read_b32 v33, v15 offset:3232
s_waitcnt lgkmcnt(0)
v_mfma_f32_32x32x2_f32 v[16:31], v32, v33, v[16:31]
ds_read_b32 v34, v14 offset:38400
ds_read_b32 v35, v15 offset:3240
s_waitcnt lgkmcnt(0)
v_mfma_f32_32x32x2_f32 v[16:31], v34, v35, v[16:31]
ds_read_b32 v36, v14 offset:38912
ds_read_b32 v37, v15 offset:3248
s_waitcnt lgkmcnt(0)
v_mfma_f32_32x32x2_f32 v[16:31], v36, v37, v[16:31]
ds_read_b32 v38, v14 offset:39424
ds_read_b32 v39, v15 offset:3256
s_waitcnt lgkmcnt(0)
v_mfma_f32_32x32x2_f32 v[16:31], v38, v39, v[16:31]
ds_read_b32 v32, v14 offset:39936
ds_read_b32 v33, v15 offset:3264
s_waitcnt lgkmcnt(0)
v_mfma_f32_32x32x2_f32 v[16:31], v32, v33, v[16:31]
ds_read_b32 v34, v14 offset:40448
ds_read_b32 v35, v15 offset:3272
s_waitcnt lgkmcnt(0)
v_mfma_f32_32x32x2_f32 v[16:31], v34, v35, v[16:31]
ds_read_b32 v36, v14 offset:40960
ds_read_b32 v37, v15 offset:3280
s_waitcnt lgkmcnt(0)
v_mfma_f32_32x32x2_f32 v[16:31], v36, v37, v[16:31]
ds_read_b32 v38, v14 offset:41472
ds_read_b32 v39, v15 offset:3288
s_waitcnt lgkmcnt(0)
v_mfma_f32_32x32x2_f32 v[16:31], v38, v39, v[16:31]
ds_read_b32 v32, v14 offset:41984
ds_read_b32 v33, v15 offset:3296
s_waitcnt lgkmcnt(0)
v_mfma_f32_32x32x2_f32 v[16:31], v32, v33, v[16:31]
ds_read_b32 v34, v14 offset:42496
ds_read_b32 v35, v15 offset:3304
s_waitcnt lgkmcnt(0)
v_mfma_f32_32x32x2_f32 v[16:31], v34, v35, v[16:31]
ds_read_b32 v36, v14 offset:43008
ds_read_b32 v37, v15 offset:3312
s_waitcnt lgkmcnt(0)
v_mfma_f32_32x32x2_f32 v[16:31], v36, v37, v[16:31]
ds_read_b32 v38, v14 offset:43520
ds_read_b32 v39, v15 offset:3320
s_waitcnt lgkmcnt(0)
v_mfma_f32_32x32x2_f32 v[16:31], v38, v39, v[16:31]
s_nop 15
s_nop 7
s_lshl_b32 s30, s2, 13
s_lshl_b32 s31, s27, 12
s_add_u32 s30, s30, s31
s_lshl_b32 s31, s26, 6
s_add_u32 s30, s30, s31
v_lshlrev_b32 v12, 7, v12
v_lshl_add_u32 v12, v13, 3, v12
v_cvt_pk_bf16_f32 v40, v16, v17
v_cvt_pk_bf16_f32 v41, v18, v19
buffer_store_dwordx2 v[40:41], v12, s[8:11], s30 offen offset:0
v_cvt_pk_bf16_f32 v42, v20, v21
v_cvt_pk_bf16_f32 v43, v22, v23
buffer_store_dwordx2 v[42:43], v12, s[8:11], s30 offen offset:16
v_cvt_pk_bf16_f32 v44, v24, v25
v_cvt_pk_bf16_f32 v45, v26, v27
buffer_store_dwordx2 v[44:45], v12, s[8:11], s30 offen offset:32
v_cvt_pk_bf16_f32 v46, v28, v29
v_cvt_pk_bf16_f32 v47, v30, v31
buffer_store_dwordx2 v[46:47], v12, s[8:11], s30 offen offset:48
K2_END:
s_endpgm
.section .rodata,"a"
.p2align 6
.amdhsa_kernel spmm_k1_kernel
  .amdhsa_next_free_vgpr 96
  .amdhsa_next_free_sgpr 64
  .amdhsa_accum_offset 96
  .amdhsa_group_segment_fixed_size 0
  .amdhsa_kernarg_size 64
  .amdhsa_user_sgpr_count 2
  .amdhsa_user_sgpr_kernarg_segment_ptr 1
  .amdhsa_system_sgpr_workgroup_id_x 1
.end_amdhsa_kernel
.section .rodata,"a"
.p2align 6
.amdhsa_kernel spmm_k2_kernel
  .amdhsa_next_free_vgpr 64
  .amdhsa_next_free_sgpr 64
  .amdhsa_accum_offset 64
  .amdhsa_group_segment_fixed_size 0
  .amdhsa_kernarg_size 64
  .amdhsa_user_sgpr_count 2
  .amdhsa_user_sgpr_kernarg_segment_ptr 1
  .amdhsa_system_sgpr_workgroup_id_x 1
.end_amdhsa_kernel
```

```asm
; @launch kernel=spmm_k1_kernel grid=(196,1,1) block=(256,1,1) lds=37120
; @launch kernel=spmm_k2_kernel grid=(782,1,1) block=(512,1,1) lds=46352
.amdgcn_target "amdgcn-amd-amdhsa--gfx950"
.text
.globl spmm_k1_kernel
.p2align 8
.type spmm_k1_kernel,@function
spmm_k1_kernel:
s_cmp_ge_u32 s2, 196
s_cbranch_scc1 K1_END
s_load_dwordx2 s[6:7], s[0:1], 8
s_load_dwordx4 s[8:11], s[0:1], 16
s_load_dwordx2 s[14:15], s[0:1], 56
s_waitcnt lgkmcnt(0)
s_mov_b32 s16, s8
s_mov_b32 s17, s9
s_mov_b32 s18, 0x30d400
s_mov_b32 s19, 0x00020000
s_mov_b32 s20, s6
s_mov_b32 s21, s7
s_mov_b32 s22, 0x30d400
s_mov_b32 s23, 0x00020000
s_mov_b32 s24, s10
s_mov_b32 s25, s11
s_mov_b32 s26, 0x186a00
s_mov_b32 s27, 0x00020000
s_add_u32 s28, s14, 0x800000
s_addc_u32 s29, s15, 0
s_mov_b32 s30, 0x620000
s_mov_b32 s31, 0x00020000
s_add_u32 s32, s14, 0x1000000
s_addc_u32 s33, s15, 0
s_mov_b32 s34, 0xc4000
s_mov_b32 s35, 0x00020000
s_mul_i32 s36, s2, 4096
v_lshlrev_b32 v1, 2, v0
v_add_u32 v1, s36, v1
v_lshlrev_b32 v2, 2, v1
v_lshlrev_b32 v3, 1, v1
v_mov_b32 v4, 0
v_mov_b32 v5, 0
v_mov_b32 v6, 0
v_mov_b32 v7, 0
v_lshlrev_b32 v8, 4, v0
ds_write_b128 v8, v[4:7] offset:0
s_mov_b32 s37, 4096
s_mov_b32 s45, 2048
s_mov_b32 s38, 8192
s_mov_b32 s46, 4096
s_mov_b32 s39, 12288
s_mov_b32 s47, 6144
buffer_load_dwordx4 v[12:15], v2, s[16:19], 0 offen
buffer_load_dwordx4 v[16:19], v2, s[16:19], s37 offen
buffer_load_dwordx4 v[20:23], v2, s[16:19], s38 offen
buffer_load_dwordx4 v[24:27], v2, s[16:19], s39 offen
buffer_load_dwordx4 v[28:31], v2, s[20:23], 0 offen
buffer_load_dwordx4 v[32:35], v2, s[20:23], s37 offen
buffer_load_dwordx4 v[36:39], v2, s[20:23], s38 offen
buffer_load_dwordx4 v[40:43], v2, s[20:23], s39 offen
buffer_load_dwordx2 v[44:45], v3, s[24:27], 0 offen
buffer_load_dwordx2 v[46:47], v3, s[24:27], s45 offen
buffer_load_dwordx2 v[48:49], v3, s[24:27], s46 offen
buffer_load_dwordx2 v[50:51], v3, s[24:27], s47 offen
s_mov_b32 s52, 0xffff0000
v_mov_b32 v9, 1
v_mov_b32 v10, 1023
s_waitcnt lgkmcnt(0)
s_barrier
s_waitcnt vmcnt(0)
v_add_u32 v11, 0, v1
v_cmp_gt_u32 vcc, 800000, v11
v_lshrrev_b32 v52, 6, v12
v_and_b32 v12, 63, v12
v_cndmask_b32 v52, v10, v52, vcc
v_lshlrev_b32 v52, 2, v52
v_lshl_or_b32 v28, v44, 16, v28
ds_add_rtn_u32 v68, v52, v9 offset:0
v_lshrrev_b32 v53, 6, v13
v_and_b32 v13, 63, v13
v_cndmask_b32 v53, v10, v53, vcc
v_lshlrev_b32 v53, 2, v53
v_and_or_b32 v29, v44, s52, v29
ds_add_rtn_u32 v69, v53, v9 offset:0
v_lshrrev_b32 v54, 6, v14
v_and_b32 v14, 63, v14
v_cndmask_b32 v54, v10, v54, vcc
v_lshlrev_b32 v54, 2, v54
v_lshl_or_b32 v30, v45, 16, v30
ds_add_rtn_u32 v70, v54, v9 offset:0
v_lshrrev_b32 v55, 6, v15
v_and_b32 v15, 63, v15
v_cndmask_b32 v55, v10, v55, vcc
v_lshlrev_b32 v55, 2, v55
v_and_or_b32 v31, v45, s52, v31
ds_add_rtn_u32 v71, v55, v9 offset:0
v_add_u32 v11, 1024, v1
v_cmp_gt_u32 vcc, 800000, v11
v_lshrrev_b32 v56, 6, v16
v_and_b32 v16, 63, v16
v_cndmask_b32 v56, v10, v56, vcc
v_lshlrev_b32 v56, 2, v56
v_lshl_or_b32 v32, v46, 16, v32
ds_add_rtn_u32 v72, v56, v9 offset:0
v_lshrrev_b32 v57, 6, v17
v_and_b32 v17, 63, v17
v_cndmask_b32 v57, v10, v57, vcc
v_lshlrev_b32 v57, 2, v57
v_and_or_b32 v33, v46, s52, v33
ds_add_rtn_u32 v73, v57, v9 offset:0
v_lshrrev_b32 v58, 6, v18
v_and_b32 v18, 63, v18
v_cndmask_b32 v58, v10, v58, vcc
v_lshlrev_b32 v58, 2, v58
v_lshl_or_b32 v34, v47, 16, v34
ds_add_rtn_u32 v74, v58, v9 offset:0
v_lshrrev_b32 v59, 6, v19
v_and_b32 v19, 63, v19
v_cndmask_b32 v59, v10, v59, vcc
v_lshlrev_b32 v59, 2, v59
v_and_or_b32 v35, v47, s52, v35
ds_add_rtn_u32 v75, v59, v9 offset:0
v_add_u32 v11, 2048, v1
v_cmp_gt_u32 vcc, 800000, v11
v_lshrrev_b32 v60, 6, v20
v_and_b32 v20, 63, v20
v_cndmask_b32 v60, v10, v60, vcc
v_lshlrev_b32 v60, 2, v60
v_lshl_or_b32 v36, v48, 16, v36
ds_add_rtn_u32 v76, v60, v9 offset:0
v_lshrrev_b32 v61, 6, v21
v_and_b32 v21, 63, v21
v_cndmask_b32 v61, v10, v61, vcc
v_lshlrev_b32 v61, 2, v61
v_and_or_b32 v37, v48, s52, v37
ds_add_rtn_u32 v77, v61, v9 offset:0
v_lshrrev_b32 v62, 6, v22
v_and_b32 v22, 63, v22
v_cndmask_b32 v62, v10, v62, vcc
v_lshlrev_b32 v62, 2, v62
v_lshl_or_b32 v38, v49, 16, v38
ds_add_rtn_u32 v78, v62, v9 offset:0
v_lshrrev_b32 v63, 6, v23
v_and_b32 v23, 63, v23
v_cndmask_b32 v63, v10, v63, vcc
v_lshlrev_b32 v63, 2, v63
v_and_or_b32 v39, v49, s52, v39
ds_add_rtn_u32 v79, v63, v9 offset:0
v_add_u32 v11, 3072, v1
v_cmp_gt_u32 vcc, 800000, v11
v_lshrrev_b32 v64, 6, v24
v_and_b32 v24, 63, v24
v_cndmask_b32 v64, v10, v64, vcc
v_lshlrev_b32 v64, 2, v64
v_lshl_or_b32 v40, v50, 16, v40
ds_add_rtn_u32 v80, v64, v9 offset:0
v_lshrrev_b32 v65, 6, v25
v_and_b32 v25, 63, v25
v_cndmask_b32 v65, v10, v65, vcc
v_lshlrev_b32 v65, 2, v65
v_and_or_b32 v41, v50, s52, v41
ds_add_rtn_u32 v81, v65, v9 offset:0
v_lshrrev_b32 v66, 6, v26
v_and_b32 v26, 63, v26
v_cndmask_b32 v66, v10, v66, vcc
v_lshlrev_b32 v66, 2, v66
v_lshl_or_b32 v42, v51, 16, v42
ds_add_rtn_u32 v82, v66, v9 offset:0
v_lshrrev_b32 v67, 6, v27
v_and_b32 v27, 63, v27
v_cndmask_b32 v67, v10, v67, vcc
v_lshlrev_b32 v67, 2, v67
v_and_or_b32 v43, v51, s52, v43
ds_add_rtn_u32 v83, v67, v9 offset:0
s_waitcnt lgkmcnt(0)
s_barrier
ds_read_b128 v[4:7], v8 offset:0
s_waitcnt lgkmcnt(0)
v_add_u32 v11, v4, v5
v_add_u32 v11, v11, v6
v_add_u32 v11, v11, v7
v_mov_b32 v84, v11
s_nop 1
v_add_u32_dpp v84, v84, v84 row_shr:1 row_mask:0xf bank_mask:0xf bound_ctrl:0
s_nop 1
v_add_u32_dpp v84, v84, v84 row_shr:2 row_mask:0xf bank_mask:0xf bound_ctrl:0
s_nop 1
v_add_u32_dpp v84, v84, v84 row_shr:4 row_mask:0xf bank_mask:0xf bound_ctrl:0
s_nop 1
v_add_u32_dpp v84, v84, v84 row_shr:8 row_mask:0xf bank_mask:0xf bound_ctrl:0
s_nop 1
v_add_u32_dpp v84, v84, v84 row_bcast:15 row_mask:0xa bank_mask:0xf
s_nop 1
v_add_u32_dpp v84, v84, v84 row_bcast:31 row_mask:0xc bank_mask:0xf
s_nop 1
v_and_b32 v85, 63, v0
v_lshrrev_b32 v86, 6, v0
v_lshlrev_b32 v87, 2, v86
v_cmp_eq_u32 vcc, 63, v85
s_and_saveexec_b64 s[54:55], vcc
ds_write_b32 v87, v84 offset:4096
s_mov_b64 exec, s[54:55]
s_waitcnt lgkmcnt(0)
s_barrier
v_mov_b32 v88, 0
ds_read_b128 v[88:91], v88 offset:4096
v_readfirstlane_b32 s56, v86
s_waitcnt lgkmcnt(0)
v_sub_u32 v84, v84, v11
s_cmp_gt_u32 s56, 0
s_cselect_b32 s57, 1, 0
v_mul_lo_u32 v92, v88, s57
v_add_u32 v84, v84, v92
s_cmp_gt_u32 s56, 1
s_cselect_b32 s57, 1, 0
v_mul_lo_u32 v92, v89, s57
v_add_u32 v84, v84, v92
s_cmp_gt_u32 s56, 2
s_cselect_b32 s57, 1, 0
v_mul_lo_u32 v92, v90, s57
v_add_u32 v84, v84, v92
v_mov_b32 v92, v84
v_add_u32 v93, v92, v4
v_add_u32 v94, v93, v5
v_add_u32 v95, v94, v6
ds_write_b128 v8, v[92:95] offset:0
s_lshl_b32 s57, s2, 12
buffer_store_dwordx4 v[92:95], v8, s[32:35], s57 offen
s_waitcnt lgkmcnt(0)
s_barrier
ds_read_b32 v52, v52 offset:0
ds_read_b32 v53, v53 offset:0
ds_read_b32 v54, v54 offset:0
ds_read_b32 v55, v55 offset:0
ds_read_b32 v56, v56 offset:0
ds_read_b32 v57, v57 offset:0
ds_read_b32 v58, v58 offset:0
ds_read_b32 v59, v59 offset:0
ds_read_b32 v60, v60 offset:0
ds_read_b32 v61, v61 offset:0
ds_read_b32 v62, v62 offset:0
ds_read_b32 v63, v63 offset:0
ds_read_b32 v64, v64 offset:0
ds_read_b32 v65, v65 offset:0
ds_read_b32 v66, v66 offset:0
ds_read_b32 v67, v67 offset:0
s_waitcnt lgkmcnt(0)
v_add_u32 v52, v52, v68
v_lshlrev_b32 v52, 3, v52
v_add_u32 v52, 4352, v52
ds_write2_b32 v52, v28, v12 offset0:0 offset1:1
v_add_u32 v53, v53, v69
v_lshlrev_b32 v53, 3, v53
v_add_u32 v53, 4352, v53
ds_write2_b32 v53, v29, v13 offset0:0 offset1:1
v_add_u32 v54, v54, v70
v_lshlrev_b32 v54, 3, v54
v_add_u32 v54, 4352, v54
ds_write2_b32 v54, v30, v14 offset0:0 offset1:1
v_add_u32 v55, v55, v71
v_lshlrev_b32 v55, 3, v55
v_add_u32 v55, 4352, v55
ds_write2_b32 v55, v31, v15 offset0:0 offset1:1
v_add_u32 v56, v56, v72
v_lshlrev_b32 v56, 3, v56
v_add_u32 v56, 4352, v56
ds_write2_b32 v56, v32, v16 offset0:0 offset1:1
v_add_u32 v57, v57, v73
v_lshlrev_b32 v57, 3, v57
v_add_u32 v57, 4352, v57
ds_write2_b32 v57, v33, v17 offset0:0 offset1:1
v_add_u32 v58, v58, v74
v_lshlrev_b32 v58, 3, v58
v_add_u32 v58, 4352, v58
ds_write2_b32 v58, v34, v18 offset0:0 offset1:1
v_add_u32 v59, v59, v75
v_lshlrev_b32 v59, 3, v59
v_add_u32 v59, 4352, v59
ds_write2_b32 v59, v35, v19 offset0:0 offset1:1
v_add_u32 v60, v60, v76
v_lshlrev_b32 v60, 3, v60
v_add_u32 v60, 4352, v60
ds_write2_b32 v60, v36, v20 offset0:0 offset1:1
v_add_u32 v61, v61, v77
v_lshlrev_b32 v61, 3, v61
v_add_u32 v61, 4352, v61
ds_write2_b32 v61, v37, v21 offset0:0 offset1:1
v_add_u32 v62, v62, v78
v_lshlrev_b32 v62, 3, v62
v_add_u32 v62, 4352, v62
ds_write2_b32 v62, v38, v22 offset0:0 offset1:1
v_add_u32 v63, v63, v79
v_lshlrev_b32 v63, 3, v63
v_add_u32 v63, 4352, v63
ds_write2_b32 v63, v39, v23 offset0:0 offset1:1
v_add_u32 v64, v64, v80
v_lshlrev_b32 v64, 3, v64
v_add_u32 v64, 4352, v64
ds_write2_b32 v64, v40, v24 offset0:0 offset1:1
v_add_u32 v65, v65, v81
v_lshlrev_b32 v65, 3, v65
v_add_u32 v65, 4352, v65
ds_write2_b32 v65, v41, v25 offset0:0 offset1:1
v_add_u32 v66, v66, v82
v_lshlrev_b32 v66, 3, v66
v_add_u32 v66, 4352, v66
ds_write2_b32 v66, v42, v26 offset0:0 offset1:1
v_add_u32 v67, v67, v83
v_lshlrev_b32 v67, 3, v67
v_add_u32 v67, 4352, v67
ds_write2_b32 v67, v43, v27 offset0:0 offset1:1
s_waitcnt lgkmcnt(0)
s_barrier
s_mul_i32 s57, s2, 32768
ds_read_b128 v[12:15], v8 offset:4352
ds_read_b128 v[16:19], v8 offset:8448
ds_read_b128 v[20:23], v8 offset:12544
ds_read_b128 v[24:27], v8 offset:16640
ds_read_b128 v[28:31], v8 offset:20736
ds_read_b128 v[32:35], v8 offset:24832
ds_read_b128 v[36:39], v8 offset:28928
ds_read_b128 v[40:43], v8 offset:33024
s_waitcnt lgkmcnt(7)
buffer_store_dwordx4 v[12:15], v8, s[28:31], s57 offen
s_waitcnt lgkmcnt(6)
s_add_u32 s58, s57, 4096
buffer_store_dwordx4 v[16:19], v8, s[28:31], s58 offen
s_waitcnt lgkmcnt(5)
s_add_u32 s58, s57, 8192
buffer_store_dwordx4 v[20:23], v8, s[28:31], s58 offen
s_waitcnt lgkmcnt(4)
s_add_u32 s58, s57, 12288
buffer_store_dwordx4 v[24:27], v8, s[28:31], s58 offen
s_waitcnt lgkmcnt(3)
s_add_u32 s58, s57, 16384
buffer_store_dwordx4 v[28:31], v8, s[28:31], s58 offen
s_waitcnt lgkmcnt(2)
s_add_u32 s58, s57, 20480
buffer_store_dwordx4 v[32:35], v8, s[28:31], s58 offen
s_waitcnt lgkmcnt(1)
s_add_u32 s58, s57, 24576
buffer_store_dwordx4 v[36:39], v8, s[28:31], s58 offen
s_waitcnt lgkmcnt(0)
s_add_u32 s58, s57, 28672
buffer_store_dwordx4 v[40:43], v8, s[28:31], s58 offen
K1_END:
s_endpgm
.globl spmm_k2_kernel
.p2align 8
.type spmm_k2_kernel,@function
spmm_k2_kernel:
s_cmp_ge_u32 s2, 782
s_cbranch_scc1 K2_END
s_load_dwordx2 s[4:5], s[0:1], 40
s_load_dwordx2 s[6:7], s[0:1], 56
s_load_dwordx2 s[44:45], s[0:1], 0
s_load_dwordx2 s[46:47], s[0:1], 32
s_waitcnt lgkmcnt(0)
s_mov_b32 s8, s4
s_mov_b32 s9, s5
s_mov_b32 s10, 0x61a800
s_mov_b32 s11, 0x00020000
s_mov_b32 s12, s44
s_mov_b32 s13, s45
s_mov_b32 s14, 0x61a800
s_mov_b32 s15, 0x00020000
s_add_u32 s16, s6, 0x800000
s_addc_u32 s17, s7, 0
s_mov_b32 s18, 0x620000
s_mov_b32 s19, 0x00020000
s_add_u32 s20, s6, 0x1000000
s_addc_u32 s21, s7, 0
s_mov_b32 s22, 0xc4000
s_mov_b32 s23, 0x00020000
s_mov_b32 s48, s46
s_mov_b32 s49, s47
s_mov_b32 s50, 0x2000
s_mov_b32 s51, 0x00020000
v_and_b32 v1, 63, v0
v_lshrrev_b32 v2, 6, v0
v_lshrrev_b32 v3, 3, v0
v_and_b32 v4, 7, v0
s_lshl_b32 s24, s2, 2
v_lshlrev_b32 v5, 12, v0
buffer_load_dwordx2 v[6:7], v5, s[20:23], s24 offen
v_lshlrev_b32 v12, 4, v0
buffer_load_dwordx4 v[16:19], v12, s[48:51], 0 offen
v_readfirstlane_b32 s25, v2
v_mov_b32 v13, 0
v_lshlrev_b32 v11, 2, v0
v_cmp_gt_u32 vcc, 64, v0
s_and_saveexec_b64 s[26:27], vcc
ds_write_b32 v11, v13 offset:0
s_mov_b64 exec, s[26:27]
s_waitcnt vmcnt(1)
v_sub_u32 v8, v7, v6
v_mov_b32 v9, v8
s_nop 1
v_add_u32_dpp v9, v9, v9 row_shr:1 row_mask:0xf bank_mask:0xf bound_ctrl:0
s_nop 1
v_add_u32_dpp v9, v9, v9 row_shr:2 row_mask:0xf bank_mask:0xf bound_ctrl:0
s_nop 1
v_add_u32_dpp v9, v9, v9 row_shr:4 row_mask:0xf bank_mask:0xf bound_ctrl:0
s_nop 1
v_add_u32_dpp v9, v9, v9 row_shr:8 row_mask:0xf bank_mask:0xf bound_ctrl:0
s_nop 1
v_add_u32_dpp v9, v9, v9 row_bcast:15 row_mask:0xa bank_mask:0xf
s_nop 1
v_add_u32_dpp v9, v9, v9 row_bcast:31 row_mask:0xc bank_mask:0xf
s_nop 1
v_lshlrev_b32 v10, 2, v2
v_cmp_eq_u32 vcc, 63, v1
s_and_saveexec_b64 s[26:27], vcc
ds_write_b32 v10, v9 offset:512
s_mov_b64 exec, s[26:27]
s_waitcnt vmcnt(0)
v_mul_u32_u24 v12, 1152, v4
v_lshl_add_u32 v12, v3, 1, v12
v_lshrrev_b32 v20, 16, v16
ds_write_b16 v12, v16 offset:37136
ds_write_b16 v12, v20 offset:37280
v_lshrrev_b32 v20, 16, v17
ds_write_b16 v12, v17 offset:37424
ds_write_b16 v12, v20 offset:37568
v_lshrrev_b32 v20, 16, v18
ds_write_b16 v12, v18 offset:37712
ds_write_b16 v12, v20 offset:37856
v_lshrrev_b32 v20, 16, v19
ds_write_b16 v12, v19 offset:38000
ds_write_b16 v12, v20 offset:38144
v_mov_b32 v20, 0
v_mov_b32 v21, 0
v_mov_b32 v22, 0
v_mov_b32 v23, 0
v_lshlrev_b32 v12, 5, v0
ds_write_b128 v12, v[20:23] offset:19456
ds_write_b128 v12, v[20:23] offset:19472
v_lshlrev_b32 v12, 4, v0
v_cmp_gt_u32 vcc, 81, v0
s_and_saveexec_b64 s[26:27], vcc
ds_write_b128 v12, v[20:23] offset:35840
s_mov_b64 exec, s[26:27]
s_waitcnt lgkmcnt(0)
s_barrier
v_mov_b32 v10, 0
ds_read_b128 v[12:15], v10 offset:512
ds_read_b128 v[16:19], v10 offset:528
s_waitcnt lgkmcnt(0)
v_readfirstlane_b32 s28, v12
v_readfirstlane_b32 s29, v13
v_readfirstlane_b32 s30, v14
v_readfirstlane_b32 s31, v15
v_readfirstlane_b32 s32, v16
v_readfirstlane_b32 s33, v17
v_readfirstlane_b32 s34, v18
v_readfirstlane_b32 s35, v19
s_nop 4
s_mov_b32 s36, 0
s_mov_b32 s37, 0
s_cmp_gt_u32 s25, 0
s_cselect_b32 s38, s28, 0
s_add_u32 s36, s36, s38
s_add_u32 s37, s37, s28
s_cmp_gt_u32 s25, 1
s_cselect_b32 s38, s29, 0
s_add_u32 s36, s36, s38
s_add_u32 s37, s37, s29
s_cmp_gt_u32 s25, 2
s_cselect_b32 s38, s30, 0
s_add_u32 s36, s36, s38
s_add_u32 s37, s37, s30
s_cmp_gt_u32 s25, 3
s_cselect_b32 s38, s31, 0
s_add_u32 s36, s36, s38
s_add_u32 s37, s37, s31
s_cmp_gt_u32 s25, 4
s_cselect_b32 s38, s32, 0
s_add_u32 s36, s36, s38
s_add_u32 s37, s37, s32
s_cmp_gt_u32 s25, 5
s_cselect_b32 s38, s33, 0
s_add_u32 s36, s36, s38
s_add_u32 s37, s37, s33
s_cmp_gt_u32 s25, 6
s_cselect_b32 s38, s34, 0
s_add_u32 s36, s36, s38
s_add_u32 s37, s37, s34
s_cmp_gt_u32 s25, 7
s_cselect_b32 s38, s35, 0
s_add_u32 s36, s36, s38
s_add_u32 s37, s37, s35
v_sub_u32 v9, v9, v8
v_add_u32 v9, s36, v9
v_mul_u32_u24 v10, 4096, v0
v_add_u32 v10, v10, v6
v_sub_u32 v10, v10, v9
v_cmp_gt_u32 vcc, 256, v0
s_and_saveexec_b64 s[26:27], vcc
ds_write_b32 v11, v9 offset:1024
ds_write_b32 v11, v10 offset:2048
s_mov_b64 exec, s[26:27]
v_mov_b32 v40, 0
v_mov_b32 v41, 0
v_mov_b32 v42, 0
v_mov_b32 v43, 0
v_mov_b32 v44, 0
v_mov_b32 v45, 0
v_mov_b32 v46, 0
v_mov_b32 v47, 0
s_mov_b32 s39, 0
s_mov_b32 s42, 0xffff0000
K2_BATCH:
s_sub_u32 s40, s37, s39
s_min_u32 s40, s40, 1024
s_waitcnt lgkmcnt(0)
s_barrier
s_mov_b32 s41, 0
K2_PB:
v_add_u32 v12, s41, v0
v_add_u32 v13, 512, v12
v_add_u32 v14, s39, v12
v_add_u32 v15, s39, v13
v_mov_b32 v16, 0
v_mov_b32 v17, 0
v_add_u32 v18, 128, v16
v_add_u32 v19, 128, v17
v_lshlrev_b32 v20, 2, v18
v_lshlrev_b32 v21, 2, v19
ds_read_b32 v20, v20 offset:1024
ds_read_b32 v21, v21 offset:1024
s_waitcnt lgkmcnt(1)
v_cmp_le_u32 vcc, v20, v14
s_waitcnt lgkmcnt(0)
v_cmp_le_u32 s[52:53], v21, v15
s_nop 1
v_cndmask_b32 v16, v16, v18, vcc
v_cndmask_b32 v17, v17, v19, s[52:53]
v_add_u32 v18, 64, v16
v_add_u32 v19, 64, v17
v_lshlrev_b32 v20, 2, v18
v_lshlrev_b32 v21, 2, v19
ds_read_b32 v20, v20 offset:1024
ds_read_b32 v21, v21 offset:1024
s_waitcnt lgkmcnt(1)
v_cmp_le_u32 vcc, v20, v14
s_waitcnt lgkmcnt(0)
v_cmp_le_u32 s[52:53], v21, v15
s_nop 1
v_cndmask_b32 v16, v16, v18, vcc
v_cndmask_b32 v17, v17, v19, s[52:53]
v_add_u32 v18, 32, v16
v_add_u32 v19, 32, v17
v_lshlrev_b32 v20, 2, v18
v_lshlrev_b32 v21, 2, v19
ds_read_b32 v20, v20 offset:1024
ds_read_b32 v21, v21 offset:1024
s_waitcnt lgkmcnt(1)
v_cmp_le_u32 vcc, v20, v14
s_waitcnt lgkmcnt(0)
v_cmp_le_u32 s[52:53], v21, v15
s_nop 1
v_cndmask_b32 v16, v16, v18, vcc
v_cndmask_b32 v17, v17, v19, s[52:53]
v_add_u32 v18, 16, v16
v_add_u32 v19, 16, v17
v_lshlrev_b32 v20, 2, v18
v_lshlrev_b32 v21, 2, v19
ds_read_b32 v20, v20 offset:1024
ds_read_b32 v21, v21 offset:1024
s_waitcnt lgkmcnt(1)
v_cmp_le_u32 vcc, v20, v14
s_waitcnt lgkmcnt(0)
v_cmp_le_u32 s[52:53], v21, v15
s_nop 1
v_cndmask_b32 v16, v16, v18, vcc
v_cndmask_b32 v17, v17, v19, s[52:53]
v_add_u32 v18, 8, v16
v_add_u32 v19, 8, v17
v_lshlrev_b32 v20, 2, v18
v_lshlrev_b32 v21, 2, v19
ds_read_b32 v20, v20 offset:1024
ds_read_b32 v21, v21 offset:1024
s_waitcnt lgkmcnt(1)
v_cmp_le_u32 vcc, v20, v14
s_waitcnt lgkmcnt(0)
v_cmp_le_u32 s[52:53], v21, v15
s_nop 1
v_cndmask_b32 v16, v16, v18, vcc
v_cndmask_b32 v17, v17, v19, s[52:53]
v_add_u32 v18, 4, v16
v_add_u32 v19, 4, v17
v_lshlrev_b32 v20, 2, v18
v_lshlrev_b32 v21, 2, v19
ds_read_b32 v20, v20 offset:1024
ds_read_b32 v21, v21 offset:1024
s_waitcnt lgkmcnt(1)
v_cmp_le_u32 vcc, v20, v14
s_waitcnt lgkmcnt(0)
v_cmp_le_u32 s[52:53], v21, v15
s_nop 1
v_cndmask_b32 v16, v16, v18, vcc
v_cndmask_b32 v17, v17, v19, s[52:53]
v_add_u32 v18, 2, v16
v_add_u32 v19, 2, v17
v_lshlrev_b32 v20, 2, v18
v_lshlrev_b32 v21, 2, v19
ds_read_b32 v20, v20 offset:1024
ds_read_b32 v21, v21 offset:1024
s_waitcnt lgkmcnt(1)
v_cmp_le_u32 vcc, v20, v14
s_waitcnt lgkmcnt(0)
v_cmp_le_u32 s[52:53], v21, v15
s_nop 1
v_cndmask_b32 v16, v16, v18, vcc
v_cndmask_b32 v17, v17, v19, s[52:53]
v_add_u32 v18, 1, v16
v_add_u32 v19, 1, v17
v_lshlrev_b32 v20, 2, v18
v_lshlrev_b32 v21, 2, v19
ds_read_b32 v20, v20 offset:1024
ds_read_b32 v21, v21 offset:1024
s_waitcnt lgkmcnt(1)
v_cmp_le_u32 vcc, v20, v14
s_waitcnt lgkmcnt(0)
v_cmp_le_u32 s[52:53], v21, v15
s_nop 1
v_cndmask_b32 v16, v16, v18, vcc
v_cndmask_b32 v17, v17, v19, s[52:53]
v_lshlrev_b32 v20, 2, v16
v_lshlrev_b32 v21, 2, v17
ds_read_b32 v20, v20 offset:2048
ds_read_b32 v21, v21 offset:2048
v_cmp_gt_u32 s[52:53], s40, v12
v_cmp_gt_u32 s[54:55], s40, v13
v_mov_b32 v22, 0x7ffffff0
s_waitcnt lgkmcnt(0)
v_add_u32 v20, v20, v14
v_add_u32 v21, v21, v15
v_lshlrev_b32 v20, 3, v20
v_lshlrev_b32 v21, 3, v21
v_cndmask_b32 v20, v22, v20, s[52:53]
v_cndmask_b32 v21, v22, v21, s[54:55]
buffer_load_dwordx2 v[24:25], v20, s[16:19], 0 offen
buffer_load_dwordx2 v[26:27], v21, s[16:19], 0 offen
v_mov_b32 v23, 1
s_mov_b64 s[56:57], exec
s_waitcnt vmcnt(1)
v_lshlrev_b32 v28, 2, v25
s_mov_b64 exec, s[52:53]
ds_add_rtn_u32 v30, v28, v23 offset:0
s_mov_b64 exec, s[56:57]
s_waitcnt vmcnt(0)
v_lshlrev_b32 v29, 2, v27
s_mov_b64 exec, s[54:55]
ds_add_rtn_u32 v31, v29, v23 offset:0
s_mov_b64 exec, s[56:57]
v_lshlrev_b32 v28, 3, v12
v_lshlrev_b32 v29, 3, v13
s_waitcnt lgkmcnt(0)
v_lshl_or_b32 v25, v30, 6, v25
v_lshl_or_b32 v27, v31, 6, v27
s_mov_b64 exec, s[52:53]
ds_write_b64 v28, v[24:25] offset:3072
s_mov_b64 exec, s[54:55]
ds_write_b64 v29, v[26:27] offset:3072
s_mov_b64 exec, s[56:57]
s_add_u32 s41, s41, 1024
s_cmp_lt_u32 s41, s40
s_cbranch_scc1 K2_PB
s_waitcnt lgkmcnt(0)
s_barrier
s_cmp_lg_u32 s25, 0
s_cbranch_scc1 K2_SCAN_DONE
v_lshlrev_b32 v12, 2, v1
ds_read_b32 v13, v12 offset:0
s_waitcnt lgkmcnt(0)
v_mov_b32 v14, v13
s_nop 1
v_add_u32_dpp v14, v14, v14 row_shr:1 row_mask:0xf bank_mask:0xf bound_ctrl:0
s_nop 1
v_add_u32_dpp v14, v14, v14 row_shr:2 row_mask:0xf bank_mask:0xf bound_ctrl:0
s_nop 1
v_add_u32_dpp v14, v14, v14 row_shr:4 row_mask:0xf bank_mask:0xf bound_ctrl:0
s_nop 1
v_add_u32_dpp v14, v14, v14 row_shr:8 row_mask:0xf bank_mask:0xf bound_ctrl:0
s_nop 1
v_add_u32_dpp v14, v14, v14 row_bcast:15 row_mask:0xa bank_mask:0xf
s_nop 1
v_add_u32_dpp v14, v14, v14 row_bcast:31 row_mask:0xc bank_mask:0xf
s_nop 1
v_sub_u32 v14, v14, v13
ds_write_b32 v12, v14 offset:256
s_waitcnt lgkmcnt(0)
K2_SCAN_DONE:
s_barrier
s_mov_b32 s41, 0
K2_PC:
v_add_u32 v12, s41, v0
v_add_u32 v13, 512, v12
v_cmp_gt_u32 s[52:53], s40, v12
v_cmp_gt_u32 s[54:55], s40, v13
v_lshlrev_b32 v14, 3, v12
v_lshlrev_b32 v15, 3, v13
ds_read_b64 v[16:17], v14 offset:3072
ds_read_b64 v[18:19], v15 offset:3072
s_waitcnt lgkmcnt(0)
v_and_b32 v20, 63, v17
v_and_b32 v21, 63, v19
v_lshlrev_b32 v20, 2, v20
v_lshlrev_b32 v21, 2, v21
ds_read_b32 v20, v20 offset:256
ds_read_b32 v21, v21 offset:256
v_lshrrev_b32 v22, 6, v17
v_lshrrev_b32 v23, 6, v19
s_waitcnt lgkmcnt(0)
v_add_u32 v20, v20, v22
v_add_u32 v21, v21, v23
v_and_b32 v17, 63, v17
v_and_b32 v19, 63, v19
v_lshlrev_b32 v20, 3, v20
v_lshlrev_b32 v21, 3, v21
s_mov_b64 exec, s[52:53]
ds_write_b64 v20, v[16:17] offset:11264
s_mov_b64 exec, s[54:55]
ds_write_b64 v21, v[18:19] offset:11264
s_mov_b64 exec, s[56:57]
s_add_u32 s41, s41, 1024
s_cmp_lt_u32 s41, s40
s_cbranch_scc1 K2_PC
s_waitcnt lgkmcnt(0)
s_barrier
s_add_u32 s43, s40, 63
s_lshr_b32 s43, s43, 6
v_mul_lo_u32 v16, v3, s43
v_add_u32 v13, s43, v16
v_min_u32 v13, s40, v13
v_mov_b32 v14, 64
v_lshlrev_b32 v15, 4, v4
v_lshlrev_b32 v12, 5, v4
v_mov_b32 v48, 0
v_mov_b32 v49, 0
v_mov_b32 v50, 0
v_mov_b32 v51, 0
v_mov_b32 v52, 0
v_mov_b32 v53, 0
v_mov_b32 v54, 0
v_mov_b32 v55, 0
v_mov_b32 v56, 0
v_mov_b32 v57, 0
v_mov_b32 v58, 0
v_mov_b32 v59, 0
v_mov_b32 v60, 0
v_mov_b32 v61, 0
v_mov_b32 v62, 0
v_mov_b32 v63, 0
K2_PD:
v_add_u32 v18, 0, v16
v_cmp_lt_u32 s[60:61], v18, v13
v_lshlrev_b32 v19, 3, v18
ds_read_b64 v[24:25], v19 offset:11264
v_add_u32 v18, 1, v16
v_cmp_lt_u32 s[62:63], v18, v13
v_lshlrev_b32 v19, 3, v18
ds_read_b64 v[26:27], v19 offset:11264
v_add_u32 v18, 2, v16
v_cmp_lt_u32 s[64:65], v18, v13
v_lshlrev_b32 v19, 3, v18
ds_read_b64 v[28:29], v19 offset:11264
v_add_u32 v18, 3, v16
v_cmp_lt_u32 s[66:67], v18, v13
v_lshlrev_b32 v19, 3, v18
ds_read_b64 v[30:31], v19 offset:11264
s_waitcnt lgkmcnt(0)
v_and_b32 v19, 0xffff, v24
v_lshl_add_u32 v19, v19, 7, v15
s_mov_b64 exec, s[60:61]
buffer_load_dwordx4 v[48:51], v19, s[12:15], 0 offen
s_mov_b64 exec, s[56:57]
v_cndmask_b32 v24, 0, v24, s[60:61]
v_lshrrev_b32 v32, 16, v24
v_and_b32 v24, s42, v24
v_and_b32 v19, 0xffff, v26
v_lshl_add_u32 v19, v19, 7, v15
s_mov_b64 exec, s[62:63]
buffer_load_dwordx4 v[52:55], v19, s[12:15], 0 offen
s_mov_b64 exec, s[56:57]
v_cndmask_b32 v26, 0, v26, s[62:63]
v_lshrrev_b32 v33, 16, v26
v_and_b32 v26, s42, v26
v_and_b32 v19, 0xffff, v28
v_lshl_add_u32 v19, v19, 7, v15
s_mov_b64 exec, s[64:65]
buffer_load_dwordx4 v[56:59], v19, s[12:15], 0 offen
s_mov_b64 exec, s[56:57]
v_cndmask_b32 v28, 0, v28, s[64:65]
v_lshrrev_b32 v34, 16, v28
v_and_b32 v28, s42, v28
v_and_b32 v19, 0xffff, v30
v_lshl_add_u32 v19, v19, 7, v15
s_mov_b64 exec, s[66:67]
buffer_load_dwordx4 v[60:63], v19, s[12:15], 0 offen
s_mov_b64 exec, s[56:57]
v_cndmask_b32 v30, 0, v30, s[66:67]
v_lshrrev_b32 v35, 16, v30
v_and_b32 v30, s42, v30
v_cmp_ne_u32 vcc, v25, v14
s_and_b64 vcc, vcc, s[60:61]
s_cbranch_vccz K2_NF0
s_mov_b64 exec, vcc
v_mul_u32_u24 v18, 272, v14
v_add_u32 v18, v18, v12
ds_add_f32 v18, v40 offset:19456
v_mov_b32 v40, 0
ds_add_f32 v18, v41 offset:19460
v_mov_b32 v41, 0
ds_add_f32 v18, v42 offset:19464
v_mov_b32 v42, 0
ds_add_f32 v18, v43 offset:19468
v_mov_b32 v43, 0
ds_add_f32 v18, v44 offset:19472
v_mov_b32 v44, 0
ds_add_f32 v18, v45 offset:19476
v_mov_b32 v45, 0
ds_add_f32 v18, v46 offset:19480
v_mov_b32 v46, 0
ds_add_f32 v18, v47 offset:19484
v_mov_b32 v47, 0
v_mov_b32 v14, v25
s_mov_b64 exec, s[56:57]
K2_NF0:
s_waitcnt vmcnt(3)
v_dot2_f32_bf16 v40, v48, v32, v40
v_dot2_f32_bf16 v41, v48, v24, v41
v_dot2_f32_bf16 v42, v49, v32, v42
v_dot2_f32_bf16 v43, v49, v24, v43
v_dot2_f32_bf16 v44, v50, v32, v44
v_dot2_f32_bf16 v45, v50, v24, v45
v_dot2_f32_bf16 v46, v51, v32, v46
v_dot2_f32_bf16 v47, v51, v24, v47
v_cmp_ne_u32 vcc, v27, v14
s_and_b64 vcc, vcc, s[62:63]
s_cbranch_vccz K2_NF1
s_mov_b64 exec, vcc
v_mul_u32_u24 v18, 272, v14
v_add_u32 v18, v18, v12
ds_add_f32 v18, v40 offset:19456
v_mov_b32 v40, 0
ds_add_f32 v18, v41 offset:19460
v_mov_b32 v41, 0
ds_add_f32 v18, v42 offset:19464
v_mov_b32 v42, 0
ds_add_f32 v18, v43 offset:19468
v_mov_b32 v43, 0
ds_add_f32 v18, v44 offset:19472
v_mov_b32 v44, 0
ds_add_f32 v18, v45 offset:19476
v_mov_b32 v45, 0
ds_add_f32 v18, v46 offset:19480
v_mov_b32 v46, 0
ds_add_f32 v18, v47 offset:19484
v_mov_b32 v47, 0
v_mov_b32 v14, v27
s_mov_b64 exec, s[56:57]
K2_NF1:
s_waitcnt vmcnt(2)
v_dot2_f32_bf16 v40, v52, v33, v40
v_dot2_f32_bf16 v41, v52, v26, v41
v_dot2_f32_bf16 v42, v53, v33, v42
v_dot2_f32_bf16 v43, v53, v26, v43
v_dot2_f32_bf16 v44, v54, v33, v44
v_dot2_f32_bf16 v45, v54, v26, v45
v_dot2_f32_bf16 v46, v55, v33, v46
v_dot2_f32_bf16 v47, v55, v26, v47
v_cmp_ne_u32 vcc, v29, v14
s_and_b64 vcc, vcc, s[64:65]
s_cbranch_vccz K2_NF2
s_mov_b64 exec, vcc
v_mul_u32_u24 v18, 272, v14
v_add_u32 v18, v18, v12
ds_add_f32 v18, v40 offset:19456
v_mov_b32 v40, 0
ds_add_f32 v18, v41 offset:19460
v_mov_b32 v41, 0
ds_add_f32 v18, v42 offset:19464
v_mov_b32 v42, 0
ds_add_f32 v18, v43 offset:19468
v_mov_b32 v43, 0
ds_add_f32 v18, v44 offset:19472
v_mov_b32 v44, 0
ds_add_f32 v18, v45 offset:19476
v_mov_b32 v45, 0
ds_add_f32 v18, v46 offset:19480
v_mov_b32 v46, 0
ds_add_f32 v18, v47 offset:19484
v_mov_b32 v47, 0
v_mov_b32 v14, v29
s_mov_b64 exec, s[56:57]
K2_NF2:
s_waitcnt vmcnt(1)
v_dot2_f32_bf16 v40, v56, v34, v40
v_dot2_f32_bf16 v41, v56, v28, v41
v_dot2_f32_bf16 v42, v57, v34, v42
v_dot2_f32_bf16 v43, v57, v28, v43
v_dot2_f32_bf16 v44, v58, v34, v44
v_dot2_f32_bf16 v45, v58, v28, v45
v_dot2_f32_bf16 v46, v59, v34, v46
v_dot2_f32_bf16 v47, v59, v28, v47
v_cmp_ne_u32 vcc, v31, v14
s_and_b64 vcc, vcc, s[66:67]
s_cbranch_vccz K2_NF3
s_mov_b64 exec, vcc
v_mul_u32_u24 v18, 272, v14
v_add_u32 v18, v18, v12
ds_add_f32 v18, v40 offset:19456
v_mov_b32 v40, 0
ds_add_f32 v18, v41 offset:19460
v_mov_b32 v41, 0
ds_add_f32 v18, v42 offset:19464
v_mov_b32 v42, 0
ds_add_f32 v18, v43 offset:19468
v_mov_b32 v43, 0
ds_add_f32 v18, v44 offset:19472
v_mov_b32 v44, 0
ds_add_f32 v18, v45 offset:19476
v_mov_b32 v45, 0
ds_add_f32 v18, v46 offset:19480
v_mov_b32 v46, 0
ds_add_f32 v18, v47 offset:19484
v_mov_b32 v47, 0
v_mov_b32 v14, v31
s_mov_b64 exec, s[56:57]
K2_NF3:
s_waitcnt vmcnt(0)
v_dot2_f32_bf16 v40, v60, v35, v40
v_dot2_f32_bf16 v41, v60, v30, v41
v_dot2_f32_bf16 v42, v61, v35, v42
v_dot2_f32_bf16 v43, v61, v30, v43
v_dot2_f32_bf16 v44, v62, v35, v44
v_dot2_f32_bf16 v45, v62, v30, v45
v_dot2_f32_bf16 v46, v63, v35, v46
v_dot2_f32_bf16 v47, v63, v30, v47
v_add_u32 v16, 4, v16
v_cmp_lt_u32 vcc, v16, v13
s_nop 4
s_cbranch_vccnz K2_PD
v_mul_u32_u24 v18, 272, v14
v_add_u32 v18, v18, v12
ds_add_f32 v18, v40 offset:19456
v_mov_b32 v40, 0
ds_add_f32 v18, v41 offset:19460
v_mov_b32 v41, 0
ds_add_f32 v18, v42 offset:19464
v_mov_b32 v42, 0
ds_add_f32 v18, v43 offset:19468
v_mov_b32 v43, 0
ds_add_f32 v18, v44 offset:19472
v_mov_b32 v44, 0
ds_add_f32 v18, v45 offset:19476
v_mov_b32 v45, 0
ds_add_f32 v18, v46 offset:19480
v_mov_b32 v46, 0
ds_add_f32 v18, v47 offset:19484
v_mov_b32 v47, 0
K2_NOD:
s_add_u32 s39, s39, 1024
s_cmp_lt_u32 s39, s37
s_cbranch_scc0 K2_OUT
s_barrier
v_mov_b32 v13, 0
v_cmp_gt_u32 vcc, 64, v0
s_and_saveexec_b64 s[26:27], vcc
ds_write_b32 v11, v13 offset:0
s_mov_b64 exec, s[26:27]
s_branch K2_BATCH
K2_OUT:
s_waitcnt lgkmcnt(0)
s_barrier
s_cmp_gt_u32 s25, 3
s_cbranch_scc1 K2_END
s_and_b32 s26, s25, 1
s_lshr_b32 s27, s25, 1
v_and_b32 v12, 31, v1
v_lshrrev_b32 v13, 5, v1
s_lshl_b32 s28, s26, 5
v_add_u32 v14, s28, v12
v_mul_u32_u24 v14, 144, v14
v_lshl_add_u32 v14, v13, 4, v14
s_lshl_b32 s29, s27, 5
v_add_u32 v15, s29, v12
v_mul_u32_u24 v15, 272, v15
v_lshl_add_u32 v15, v13, 5, v15
ds_read_b128 v[32:35], v14 offset:37136
ds_read_b128 v[36:39], v15 offset:19456
ds_read_b128 v[40:43], v15 offset:19472
s_waitcnt lgkmcnt(0)
v_cvt_pk_bf16_f32 v44, v36, v37
v_cvt_pk_bf16_f32 v45, v38, v39
v_cvt_pk_bf16_f32 v46, v40, v41
v_cvt_pk_bf16_f32 v47, v42, v43
v_lshlrev_b32 v48, 16, v44
v_and_b32 v49, s42, v44
v_sub_f32 v36, v36, v48
v_sub_f32 v37, v37, v49
v_lshlrev_b32 v48, 16, v45
v_and_b32 v49, s42, v45
v_sub_f32 v38, v38, v48
v_sub_f32 v39, v39, v49
v_lshlrev_b32 v48, 16, v46
v_and_b32 v49, s42, v46
v_sub_f32 v40, v40, v48
v_sub_f32 v41, v41, v49
v_lshlrev_b32 v48, 16, v47
v_and_b32 v49, s42, v47
v_sub_f32 v42, v42, v48
v_sub_f32 v43, v43, v49
v_cvt_pk_bf16_f32 v36, v36, v37
v_cvt_pk_bf16_f32 v37, v38, v39
v_cvt_pk_bf16_f32 v38, v40, v41
v_cvt_pk_bf16_f32 v39, v42, v43
s_nop 1
v_mfma_f32_32x32x16_bf16 v[16:31], v[32:35], v[44:47], 0
v_mfma_f32_32x32x16_bf16 v[16:31], v[32:35], v[36:39], v[16:31]
ds_read_b128 v[32:35], v14 offset:37168
ds_read_b128 v[36:39], v15 offset:19520
ds_read_b128 v[40:43], v15 offset:19536
s_waitcnt lgkmcnt(0)
v_cvt_pk_bf16_f32 v44, v36, v37
v_cvt_pk_bf16_f32 v45, v38, v39
v_cvt_pk_bf16_f32 v46, v40, v41
v_cvt_pk_bf16_f32 v47, v42, v43
v_lshlrev_b32 v48, 16, v44
v_and_b32 v49, s42, v44
v_sub_f32 v36, v36, v48
v_sub_f32 v37, v37, v49
v_lshlrev_b32 v48, 16, v45
v_and_b32 v49, s42, v45
v_sub_f32 v38, v38, v48
v_sub_f32 v39, v39, v49
v_lshlrev_b32 v48, 16, v46
v_and_b32 v49, s42, v46
v_sub_f32 v40, v40, v48
v_sub_f32 v41, v41, v49
v_lshlrev_b32 v48, 16, v47
v_and_b32 v49, s42, v47
v_sub_f32 v42, v42, v48
v_sub_f32 v43, v43, v49
v_cvt_pk_bf16_f32 v36, v36, v37
v_cvt_pk_bf16_f32 v37, v38, v39
v_cvt_pk_bf16_f32 v38, v40, v41
v_cvt_pk_bf16_f32 v39, v42, v43
s_nop 1
v_mfma_f32_32x32x16_bf16 v[16:31], v[32:35], v[44:47], v[16:31]
v_mfma_f32_32x32x16_bf16 v[16:31], v[32:35], v[36:39], v[16:31]
ds_read_b128 v[32:35], v14 offset:37200
ds_read_b128 v[36:39], v15 offset:19584
ds_read_b128 v[40:43], v15 offset:19600
s_waitcnt lgkmcnt(0)
v_cvt_pk_bf16_f32 v44, v36, v37
v_cvt_pk_bf16_f32 v45, v38, v39
v_cvt_pk_bf16_f32 v46, v40, v41
v_cvt_pk_bf16_f32 v47, v42, v43
v_lshlrev_b32 v48, 16, v44
v_and_b32 v49, s42, v44
v_sub_f32 v36, v36, v48
v_sub_f32 v37, v37, v49
v_lshlrev_b32 v48, 16, v45
v_and_b32 v49, s42, v45
v_sub_f32 v38, v38, v48
v_sub_f32 v39, v39, v49
v_lshlrev_b32 v48, 16, v46
v_and_b32 v49, s42, v46
v_sub_f32 v40, v40, v48
v_sub_f32 v41, v41, v49
v_lshlrev_b32 v48, 16, v47
v_and_b32 v49, s42, v47
v_sub_f32 v42, v42, v48
v_sub_f32 v43, v43, v49
v_cvt_pk_bf16_f32 v36, v36, v37
v_cvt_pk_bf16_f32 v37, v38, v39
v_cvt_pk_bf16_f32 v38, v40, v41
v_cvt_pk_bf16_f32 v39, v42, v43
s_nop 1
v_mfma_f32_32x32x16_bf16 v[16:31], v[32:35], v[44:47], v[16:31]
v_mfma_f32_32x32x16_bf16 v[16:31], v[32:35], v[36:39], v[16:31]
ds_read_b128 v[32:35], v14 offset:37232
ds_read_b128 v[36:39], v15 offset:19648
ds_read_b128 v[40:43], v15 offset:19664
s_waitcnt lgkmcnt(0)
v_cvt_pk_bf16_f32 v44, v36, v37
v_cvt_pk_bf16_f32 v45, v38, v39
v_cvt_pk_bf16_f32 v46, v40, v41
v_cvt_pk_bf16_f32 v47, v42, v43
v_lshlrev_b32 v48, 16, v44
v_and_b32 v49, s42, v44
v_sub_f32 v36, v36, v48
v_sub_f32 v37, v37, v49
v_lshlrev_b32 v48, 16, v45
v_and_b32 v49, s42, v45
v_sub_f32 v38, v38, v48
v_sub_f32 v39, v39, v49
v_lshlrev_b32 v48, 16, v46
v_and_b32 v49, s42, v46
v_sub_f32 v40, v40, v48
v_sub_f32 v41, v41, v49
v_lshlrev_b32 v48, 16, v47
v_and_b32 v49, s42, v47
v_sub_f32 v42, v42, v48
v_sub_f32 v43, v43, v49
v_cvt_pk_bf16_f32 v36, v36, v37
v_cvt_pk_bf16_f32 v37, v38, v39
v_cvt_pk_bf16_f32 v38, v40, v41
v_cvt_pk_bf16_f32 v39, v42, v43
s_nop 1
v_mfma_f32_32x32x16_bf16 v[16:31], v[32:35], v[44:47], v[16:31]
v_mfma_f32_32x32x16_bf16 v[16:31], v[32:35], v[36:39], v[16:31]
s_nop 15
s_nop 7
s_lshl_b32 s30, s2, 13
s_lshl_b32 s31, s27, 12
s_add_u32 s30, s30, s31
s_lshl_b32 s31, s26, 6
s_add_u32 s30, s30, s31
v_lshlrev_b32 v12, 7, v12
v_lshl_add_u32 v12, v13, 3, v12
v_cvt_pk_bf16_f32 v40, v16, v17
v_cvt_pk_bf16_f32 v41, v18, v19
buffer_store_dwordx2 v[40:41], v12, s[8:11], s30 offen offset:0
v_cvt_pk_bf16_f32 v42, v20, v21
v_cvt_pk_bf16_f32 v43, v22, v23
buffer_store_dwordx2 v[42:43], v12, s[8:11], s30 offen offset:16
v_cvt_pk_bf16_f32 v44, v24, v25
v_cvt_pk_bf16_f32 v45, v26, v27
buffer_store_dwordx2 v[44:45], v12, s[8:11], s30 offen offset:32
v_cvt_pk_bf16_f32 v46, v28, v29
v_cvt_pk_bf16_f32 v47, v30, v31
buffer_store_dwordx2 v[46:47], v12, s[8:11], s30 offen offset:48
K2_END:
s_endpgm
.section .rodata,"a"
.p2align 6
.amdhsa_kernel spmm_k1_kernel
  .amdhsa_next_free_vgpr 96
  .amdhsa_next_free_sgpr 64
  .amdhsa_accum_offset 96
  .amdhsa_group_segment_fixed_size 0
  .amdhsa_kernarg_size 64
  .amdhsa_user_sgpr_count 2
  .amdhsa_user_sgpr_kernarg_segment_ptr 1
  .amdhsa_system_sgpr_workgroup_id_x 1
.end_amdhsa_kernel
.section .rodata,"a"
.p2align 6
.amdhsa_kernel spmm_k2_kernel
  .amdhsa_next_free_vgpr 64
  .amdhsa_next_free_sgpr 64
  .amdhsa_accum_offset 64
  .amdhsa_group_segment_fixed_size 0
  .amdhsa_kernarg_size 64
  .amdhsa_user_sgpr_count 2
  .amdhsa_user_sgpr_kernarg_segment_ptr 1
  .amdhsa_system_sgpr_workgroup_id_x 1
.end_amdhsa_kernel
```

```asm
; @launch kernel=spmm_k1_kernel grid=(196,1,1) block=(256,1,1) lds=37120
; @launch kernel=spmm_k2_kernel grid=(782,1,1) block=(512,1,1) lds=36864
.amdgcn_target "amdgcn-amd-amdhsa--gfx950"
.text
.globl spmm_k1_kernel
.p2align 8
.type spmm_k1_kernel,@function
spmm_k1_kernel:
s_cmp_ge_u32 s2, 196
s_cbranch_scc1 K1_END
s_load_dwordx2 s[6:7], s[0:1], 8
s_load_dwordx4 s[8:11], s[0:1], 16
s_load_dwordx2 s[14:15], s[0:1], 56
s_waitcnt lgkmcnt(0)
s_mov_b32 s16, s8
s_mov_b32 s17, s9
s_mov_b32 s18, 0x30d400
s_mov_b32 s19, 0x00020000
s_mov_b32 s20, s6
s_mov_b32 s21, s7
s_mov_b32 s22, 0x30d400
s_mov_b32 s23, 0x00020000
s_mov_b32 s24, s10
s_mov_b32 s25, s11
s_mov_b32 s26, 0x186a00
s_mov_b32 s27, 0x00020000
s_add_u32 s28, s14, 0x800000
s_addc_u32 s29, s15, 0
s_mov_b32 s30, 0x620000
s_mov_b32 s31, 0x00020000
s_add_u32 s32, s14, 0x1000000
s_addc_u32 s33, s15, 0
s_mov_b32 s34, 0xc4000
s_mov_b32 s35, 0x00020000
s_mul_i32 s36, s2, 4096
v_lshlrev_b32 v1, 2, v0
v_add_u32 v1, s36, v1
v_lshlrev_b32 v2, 2, v1
v_lshlrev_b32 v3, 1, v1
v_mov_b32 v4, 0
v_mov_b32 v5, 0
v_mov_b32 v6, 0
v_mov_b32 v7, 0
v_lshlrev_b32 v8, 4, v0
ds_write_b128 v8, v[4:7] offset:0
s_mov_b32 s37, 4096
s_mov_b32 s45, 2048
s_mov_b32 s38, 8192
s_mov_b32 s46, 4096
s_mov_b32 s39, 12288
s_mov_b32 s47, 6144
buffer_load_dwordx4 v[12:15], v2, s[16:19], 0 offen
buffer_load_dwordx4 v[16:19], v2, s[16:19], s37 offen
buffer_load_dwordx4 v[20:23], v2, s[16:19], s38 offen
buffer_load_dwordx4 v[24:27], v2, s[16:19], s39 offen
buffer_load_dwordx4 v[28:31], v2, s[20:23], 0 offen
buffer_load_dwordx4 v[32:35], v2, s[20:23], s37 offen
buffer_load_dwordx4 v[36:39], v2, s[20:23], s38 offen
buffer_load_dwordx4 v[40:43], v2, s[20:23], s39 offen
buffer_load_dwordx2 v[44:45], v3, s[24:27], 0 offen
buffer_load_dwordx2 v[46:47], v3, s[24:27], s45 offen
buffer_load_dwordx2 v[48:49], v3, s[24:27], s46 offen
buffer_load_dwordx2 v[50:51], v3, s[24:27], s47 offen
s_mov_b32 s52, 0xffff0000
v_mov_b32 v9, 1
v_mov_b32 v10, 1023
s_waitcnt lgkmcnt(0)
s_barrier
s_waitcnt vmcnt(0)
v_add_u32 v11, 0, v1
v_cmp_gt_u32 vcc, 800000, v11
v_lshrrev_b32 v52, 6, v12
v_and_b32 v12, 63, v12
v_cndmask_b32 v52, v10, v52, vcc
v_lshlrev_b32 v52, 2, v52
v_lshl_or_b32 v28, v44, 16, v28
ds_add_rtn_u32 v68, v52, v9 offset:0
v_lshrrev_b32 v53, 6, v13
v_and_b32 v13, 63, v13
v_cndmask_b32 v53, v10, v53, vcc
v_lshlrev_b32 v53, 2, v53
v_and_or_b32 v29, v44, s52, v29
ds_add_rtn_u32 v69, v53, v9 offset:0
v_lshrrev_b32 v54, 6, v14
v_and_b32 v14, 63, v14
v_cndmask_b32 v54, v10, v54, vcc
v_lshlrev_b32 v54, 2, v54
v_lshl_or_b32 v30, v45, 16, v30
ds_add_rtn_u32 v70, v54, v9 offset:0
v_lshrrev_b32 v55, 6, v15
v_and_b32 v15, 63, v15
v_cndmask_b32 v55, v10, v55, vcc
v_lshlrev_b32 v55, 2, v55
v_and_or_b32 v31, v45, s52, v31
ds_add_rtn_u32 v71, v55, v9 offset:0
v_add_u32 v11, 1024, v1
v_cmp_gt_u32 vcc, 800000, v11
v_lshrrev_b32 v56, 6, v16
v_and_b32 v16, 63, v16
v_cndmask_b32 v56, v10, v56, vcc
v_lshlrev_b32 v56, 2, v56
v_lshl_or_b32 v32, v46, 16, v32
ds_add_rtn_u32 v72, v56, v9 offset:0
v_lshrrev_b32 v57, 6, v17
v_and_b32 v17, 63, v17
v_cndmask_b32 v57, v10, v57, vcc
v_lshlrev_b32 v57, 2, v57
v_and_or_b32 v33, v46, s52, v33
ds_add_rtn_u32 v73, v57, v9 offset:0
v_lshrrev_b32 v58, 6, v18
v_and_b32 v18, 63, v18
v_cndmask_b32 v58, v10, v58, vcc
v_lshlrev_b32 v58, 2, v58
v_lshl_or_b32 v34, v47, 16, v34
ds_add_rtn_u32 v74, v58, v9 offset:0
v_lshrrev_b32 v59, 6, v19
v_and_b32 v19, 63, v19
v_cndmask_b32 v59, v10, v59, vcc
v_lshlrev_b32 v59, 2, v59
v_and_or_b32 v35, v47, s52, v35
ds_add_rtn_u32 v75, v59, v9 offset:0
v_add_u32 v11, 2048, v1
v_cmp_gt_u32 vcc, 800000, v11
v_lshrrev_b32 v60, 6, v20
v_and_b32 v20, 63, v20
v_cndmask_b32 v60, v10, v60, vcc
v_lshlrev_b32 v60, 2, v60
v_lshl_or_b32 v36, v48, 16, v36
ds_add_rtn_u32 v76, v60, v9 offset:0
v_lshrrev_b32 v61, 6, v21
v_and_b32 v21, 63, v21
v_cndmask_b32 v61, v10, v61, vcc
v_lshlrev_b32 v61, 2, v61
v_and_or_b32 v37, v48, s52, v37
ds_add_rtn_u32 v77, v61, v9 offset:0
v_lshrrev_b32 v62, 6, v22
v_and_b32 v22, 63, v22
v_cndmask_b32 v62, v10, v62, vcc
v_lshlrev_b32 v62, 2, v62
v_lshl_or_b32 v38, v49, 16, v38
ds_add_rtn_u32 v78, v62, v9 offset:0
v_lshrrev_b32 v63, 6, v23
v_and_b32 v23, 63, v23
v_cndmask_b32 v63, v10, v63, vcc
v_lshlrev_b32 v63, 2, v63
v_and_or_b32 v39, v49, s52, v39
ds_add_rtn_u32 v79, v63, v9 offset:0
v_add_u32 v11, 3072, v1
v_cmp_gt_u32 vcc, 800000, v11
v_lshrrev_b32 v64, 6, v24
v_and_b32 v24, 63, v24
v_cndmask_b32 v64, v10, v64, vcc
v_lshlrev_b32 v64, 2, v64
v_lshl_or_b32 v40, v50, 16, v40
ds_add_rtn_u32 v80, v64, v9 offset:0
v_lshrrev_b32 v65, 6, v25
v_and_b32 v25, 63, v25
v_cndmask_b32 v65, v10, v65, vcc
v_lshlrev_b32 v65, 2, v65
v_and_or_b32 v41, v50, s52, v41
ds_add_rtn_u32 v81, v65, v9 offset:0
v_lshrrev_b32 v66, 6, v26
v_and_b32 v26, 63, v26
v_cndmask_b32 v66, v10, v66, vcc
v_lshlrev_b32 v66, 2, v66
v_lshl_or_b32 v42, v51, 16, v42
ds_add_rtn_u32 v82, v66, v9 offset:0
v_lshrrev_b32 v67, 6, v27
v_and_b32 v27, 63, v27
v_cndmask_b32 v67, v10, v67, vcc
v_lshlrev_b32 v67, 2, v67
v_and_or_b32 v43, v51, s52, v43
ds_add_rtn_u32 v83, v67, v9 offset:0
s_waitcnt lgkmcnt(0)
s_barrier
ds_read_b128 v[4:7], v8 offset:0
s_waitcnt lgkmcnt(0)
v_add_u32 v11, v4, v5
v_add_u32 v11, v11, v6
v_add_u32 v11, v11, v7
v_mov_b32 v84, v11
s_nop 1
v_add_u32_dpp v84, v84, v84 row_shr:1 row_mask:0xf bank_mask:0xf bound_ctrl:0
s_nop 1
v_add_u32_dpp v84, v84, v84 row_shr:2 row_mask:0xf bank_mask:0xf bound_ctrl:0
s_nop 1
v_add_u32_dpp v84, v84, v84 row_shr:4 row_mask:0xf bank_mask:0xf bound_ctrl:0
s_nop 1
v_add_u32_dpp v84, v84, v84 row_shr:8 row_mask:0xf bank_mask:0xf bound_ctrl:0
s_nop 1
v_add_u32_dpp v84, v84, v84 row_bcast:15 row_mask:0xa bank_mask:0xf
s_nop 1
v_add_u32_dpp v84, v84, v84 row_bcast:31 row_mask:0xc bank_mask:0xf
s_nop 1
v_and_b32 v85, 63, v0
v_lshrrev_b32 v86, 6, v0
v_lshlrev_b32 v87, 2, v86
v_cmp_eq_u32 vcc, 63, v85
s_and_saveexec_b64 s[54:55], vcc
ds_write_b32 v87, v84 offset:4096
s_mov_b64 exec, s[54:55]
s_waitcnt lgkmcnt(0)
s_barrier
v_mov_b32 v88, 0
ds_read_b128 v[88:91], v88 offset:4096
v_readfirstlane_b32 s56, v86
s_waitcnt lgkmcnt(0)
v_sub_u32 v84, v84, v11
s_cmp_gt_u32 s56, 0
s_cselect_b32 s57, 1, 0
v_mul_lo_u32 v92, v88, s57
v_add_u32 v84, v84, v92
s_cmp_gt_u32 s56, 1
s_cselect_b32 s57, 1, 0
v_mul_lo_u32 v92, v89, s57
v_add_u32 v84, v84, v92
s_cmp_gt_u32 s56, 2
s_cselect_b32 s57, 1, 0
v_mul_lo_u32 v92, v90, s57
v_add_u32 v84, v84, v92
v_mov_b32 v92, v84
v_add_u32 v93, v92, v4
v_add_u32 v94, v93, v5
v_add_u32 v95, v94, v6
ds_write_b128 v8, v[92:95] offset:0
s_lshl_b32 s57, s2, 12
buffer_store_dwordx4 v[92:95], v8, s[32:35], s57 offen
s_waitcnt lgkmcnt(0)
s_barrier
ds_read_b32 v52, v52 offset:0
ds_read_b32 v53, v53 offset:0
ds_read_b32 v54, v54 offset:0
ds_read_b32 v55, v55 offset:0
ds_read_b32 v56, v56 offset:0
ds_read_b32 v57, v57 offset:0
ds_read_b32 v58, v58 offset:0
ds_read_b32 v59, v59 offset:0
ds_read_b32 v60, v60 offset:0
ds_read_b32 v61, v61 offset:0
ds_read_b32 v62, v62 offset:0
ds_read_b32 v63, v63 offset:0
ds_read_b32 v64, v64 offset:0
ds_read_b32 v65, v65 offset:0
ds_read_b32 v66, v66 offset:0
ds_read_b32 v67, v67 offset:0
s_waitcnt lgkmcnt(0)
v_add_u32 v52, v52, v68
v_lshlrev_b32 v52, 3, v52
v_add_u32 v52, 4352, v52
ds_write2_b32 v52, v28, v12 offset0:0 offset1:1
v_add_u32 v53, v53, v69
v_lshlrev_b32 v53, 3, v53
v_add_u32 v53, 4352, v53
ds_write2_b32 v53, v29, v13 offset0:0 offset1:1
v_add_u32 v54, v54, v70
v_lshlrev_b32 v54, 3, v54
v_add_u32 v54, 4352, v54
ds_write2_b32 v54, v30, v14 offset0:0 offset1:1
v_add_u32 v55, v55, v71
v_lshlrev_b32 v55, 3, v55
v_add_u32 v55, 4352, v55
ds_write2_b32 v55, v31, v15 offset0:0 offset1:1
v_add_u32 v56, v56, v72
v_lshlrev_b32 v56, 3, v56
v_add_u32 v56, 4352, v56
ds_write2_b32 v56, v32, v16 offset0:0 offset1:1
v_add_u32 v57, v57, v73
v_lshlrev_b32 v57, 3, v57
v_add_u32 v57, 4352, v57
ds_write2_b32 v57, v33, v17 offset0:0 offset1:1
v_add_u32 v58, v58, v74
v_lshlrev_b32 v58, 3, v58
v_add_u32 v58, 4352, v58
ds_write2_b32 v58, v34, v18 offset0:0 offset1:1
v_add_u32 v59, v59, v75
v_lshlrev_b32 v59, 3, v59
v_add_u32 v59, 4352, v59
ds_write2_b32 v59, v35, v19 offset0:0 offset1:1
v_add_u32 v60, v60, v76
v_lshlrev_b32 v60, 3, v60
v_add_u32 v60, 4352, v60
ds_write2_b32 v60, v36, v20 offset0:0 offset1:1
v_add_u32 v61, v61, v77
v_lshlrev_b32 v61, 3, v61
v_add_u32 v61, 4352, v61
ds_write2_b32 v61, v37, v21 offset0:0 offset1:1
v_add_u32 v62, v62, v78
v_lshlrev_b32 v62, 3, v62
v_add_u32 v62, 4352, v62
ds_write2_b32 v62, v38, v22 offset0:0 offset1:1
v_add_u32 v63, v63, v79
v_lshlrev_b32 v63, 3, v63
v_add_u32 v63, 4352, v63
ds_write2_b32 v63, v39, v23 offset0:0 offset1:1
v_add_u32 v64, v64, v80
v_lshlrev_b32 v64, 3, v64
v_add_u32 v64, 4352, v64
ds_write2_b32 v64, v40, v24 offset0:0 offset1:1
v_add_u32 v65, v65, v81
v_lshlrev_b32 v65, 3, v65
v_add_u32 v65, 4352, v65
ds_write2_b32 v65, v41, v25 offset0:0 offset1:1
v_add_u32 v66, v66, v82
v_lshlrev_b32 v66, 3, v66
v_add_u32 v66, 4352, v66
ds_write2_b32 v66, v42, v26 offset0:0 offset1:1
v_add_u32 v67, v67, v83
v_lshlrev_b32 v67, 3, v67
v_add_u32 v67, 4352, v67
ds_write2_b32 v67, v43, v27 offset0:0 offset1:1
s_waitcnt lgkmcnt(0)
s_barrier
s_mul_i32 s57, s2, 32768
ds_read_b128 v[12:15], v8 offset:4352
ds_read_b128 v[16:19], v8 offset:8448
ds_read_b128 v[20:23], v8 offset:12544
ds_read_b128 v[24:27], v8 offset:16640
ds_read_b128 v[28:31], v8 offset:20736
ds_read_b128 v[32:35], v8 offset:24832
ds_read_b128 v[36:39], v8 offset:28928
ds_read_b128 v[40:43], v8 offset:33024
s_waitcnt lgkmcnt(7)
buffer_store_dwordx4 v[12:15], v8, s[28:31], s57 offen
s_waitcnt lgkmcnt(6)
s_add_u32 s58, s57, 4096
buffer_store_dwordx4 v[16:19], v8, s[28:31], s58 offen
s_waitcnt lgkmcnt(5)
s_add_u32 s58, s57, 8192
buffer_store_dwordx4 v[20:23], v8, s[28:31], s58 offen
s_waitcnt lgkmcnt(4)
s_add_u32 s58, s57, 12288
buffer_store_dwordx4 v[24:27], v8, s[28:31], s58 offen
s_waitcnt lgkmcnt(3)
s_add_u32 s58, s57, 16384
buffer_store_dwordx4 v[28:31], v8, s[28:31], s58 offen
s_waitcnt lgkmcnt(2)
s_add_u32 s58, s57, 20480
buffer_store_dwordx4 v[32:35], v8, s[28:31], s58 offen
s_waitcnt lgkmcnt(1)
s_add_u32 s58, s57, 24576
buffer_store_dwordx4 v[36:39], v8, s[28:31], s58 offen
s_waitcnt lgkmcnt(0)
s_add_u32 s58, s57, 28672
buffer_store_dwordx4 v[40:43], v8, s[28:31], s58 offen
K1_END:
s_endpgm
.globl spmm_k2_kernel
.p2align 8
.type spmm_k2_kernel,@function
spmm_k2_kernel:
s_cmp_ge_u32 s2, 782
s_cbranch_scc1 K2_END
s_load_dwordx2 s[4:5], s[0:1], 40
s_load_dwordx2 s[6:7], s[0:1], 56
s_load_dwordx2 s[44:45], s[0:1], 0
s_load_dwordx2 s[46:47], s[0:1], 32
s_waitcnt lgkmcnt(0)
s_mov_b32 s8, s4
s_mov_b32 s9, s5
s_mov_b32 s10, 0x61a800
s_mov_b32 s11, 0x00020000
s_mov_b32 s12, s44
s_mov_b32 s13, s45
s_mov_b32 s14, 0x61a800
s_mov_b32 s15, 0x00020000
s_add_u32 s16, s6, 0x800000
s_addc_u32 s17, s7, 0
s_mov_b32 s18, 0x620000
s_mov_b32 s19, 0x00020000
s_add_u32 s20, s6, 0x1000000
s_addc_u32 s21, s7, 0
s_mov_b32 s22, 0xc4000
s_mov_b32 s23, 0x00020000
s_mov_b32 s48, s46
s_mov_b32 s49, s47
s_mov_b32 s50, 0x2000
s_mov_b32 s51, 0x00020000
v_and_b32 v1, 63, v0
v_lshrrev_b32 v2, 6, v0
v_lshrrev_b32 v3, 3, v0
v_and_b32 v4, 7, v0
s_lshl_b32 s24, s2, 2
v_lshlrev_b32 v5, 12, v0
buffer_load_dwordx2 v[6:7], v5, s[20:23], s24 offen
v_lshlrev_b32 v12, 4, v0
buffer_load_dwordx4 v[16:19], v12, s[48:51], 0 offen
v_readfirstlane_b32 s25, v2
v_mov_b32 v13, 0
v_lshlrev_b32 v11, 2, v0
v_cmp_gt_u32 vcc, 64, v0
s_and_saveexec_b64 s[26:27], vcc
ds_write_b32 v11, v13 offset:0
s_mov_b64 exec, s[26:27]
s_waitcnt vmcnt(1)
v_sub_u32 v8, v7, v6
v_mov_b32 v9, v8
s_nop 1
v_add_u32_dpp v9, v9, v9 row_shr:1 row_mask:0xf bank_mask:0xf bound_ctrl:0
s_nop 1
v_add_u32_dpp v9, v9, v9 row_shr:2 row_mask:0xf bank_mask:0xf bound_ctrl:0
s_nop 1
v_add_u32_dpp v9, v9, v9 row_shr:4 row_mask:0xf bank_mask:0xf bound_ctrl:0
s_nop 1
v_add_u32_dpp v9, v9, v9 row_shr:8 row_mask:0xf bank_mask:0xf bound_ctrl:0
s_nop 1
v_add_u32_dpp v9, v9, v9 row_bcast:15 row_mask:0xa bank_mask:0xf
s_nop 1
v_add_u32_dpp v9, v9, v9 row_bcast:31 row_mask:0xc bank_mask:0xf
s_nop 1
v_lshlrev_b32 v10, 2, v2
v_cmp_eq_u32 vcc, 63, v1
s_and_saveexec_b64 s[26:27], vcc
ds_write_b32 v10, v9 offset:512
s_mov_b64 exec, s[26:27]
s_waitcnt vmcnt(0)
v_mul_u32_u24 v12, 1152, v4
v_lshl_add_u32 v12, v3, 1, v12
v_lshrrev_b32 v20, 16, v16
ds_write_b16 v12, v16 offset:27648
ds_write_b16 v12, v20 offset:27792
v_lshrrev_b32 v20, 16, v17
ds_write_b16 v12, v17 offset:27936
ds_write_b16 v12, v20 offset:28080
v_lshrrev_b32 v20, 16, v18
ds_write_b16 v12, v18 offset:28224
ds_write_b16 v12, v20 offset:28368
v_lshrrev_b32 v20, 16, v19
ds_write_b16 v12, v19 offset:28512
ds_write_b16 v12, v20 offset:28656
v_mov_b32 v20, 0
v_mov_b32 v21, 0
v_mov_b32 v22, 0
v_mov_b32 v23, 0
v_lshlrev_b32 v12, 5, v0
ds_write_b128 v12, v[20:23] offset:3072
ds_write_b128 v12, v[20:23] offset:3088
v_lshlrev_b32 v12, 4, v0
v_cmp_gt_u32 vcc, 81, v0
s_and_saveexec_b64 s[26:27], vcc
ds_write_b128 v12, v[20:23] offset:19456
s_mov_b64 exec, s[26:27]
s_waitcnt lgkmcnt(0)
s_barrier
v_mov_b32 v10, 0
ds_read_b128 v[12:15], v10 offset:512
ds_read_b128 v[16:19], v10 offset:528
s_waitcnt lgkmcnt(0)
v_readfirstlane_b32 s28, v12
v_readfirstlane_b32 s29, v13
v_readfirstlane_b32 s30, v14
v_readfirstlane_b32 s31, v15
v_readfirstlane_b32 s32, v16
v_readfirstlane_b32 s33, v17
v_readfirstlane_b32 s34, v18
v_readfirstlane_b32 s35, v19
s_nop 4
s_mov_b32 s36, 0
s_mov_b32 s37, 0
s_cmp_gt_u32 s25, 0
s_cselect_b32 s38, s28, 0
s_add_u32 s36, s36, s38
s_add_u32 s37, s37, s28
s_cmp_gt_u32 s25, 1
s_cselect_b32 s38, s29, 0
s_add_u32 s36, s36, s38
s_add_u32 s37, s37, s29
s_cmp_gt_u32 s25, 2
s_cselect_b32 s38, s30, 0
s_add_u32 s36, s36, s38
s_add_u32 s37, s37, s30
s_cmp_gt_u32 s25, 3
s_cselect_b32 s38, s31, 0
s_add_u32 s36, s36, s38
s_add_u32 s37, s37, s31
s_cmp_gt_u32 s25, 4
s_cselect_b32 s38, s32, 0
s_add_u32 s36, s36, s38
s_add_u32 s37, s37, s32
s_cmp_gt_u32 s25, 5
s_cselect_b32 s38, s33, 0
s_add_u32 s36, s36, s38
s_add_u32 s37, s37, s33
s_cmp_gt_u32 s25, 6
s_cselect_b32 s38, s34, 0
s_add_u32 s36, s36, s38
s_add_u32 s37, s37, s34
s_cmp_gt_u32 s25, 7
s_cselect_b32 s38, s35, 0
s_add_u32 s36, s36, s38
s_add_u32 s37, s37, s35
v_sub_u32 v9, v9, v8
v_add_u32 v9, s36, v9
v_mul_u32_u24 v10, 4096, v0
v_add_u32 v10, v10, v6
v_sub_u32 v10, v10, v9
v_cmp_gt_u32 vcc, 256, v0
s_and_saveexec_b64 s[26:27], vcc
ds_write_b32 v11, v9 offset:1024
ds_write_b32 v11, v10 offset:2048
s_mov_b64 exec, s[26:27]
v_mov_b32 v40, 0
v_mov_b32 v41, 0
v_mov_b32 v42, 0
v_mov_b32 v43, 0
v_mov_b32 v44, 0
v_mov_b32 v45, 0
v_mov_b32 v46, 0
v_mov_b32 v47, 0
s_mov_b32 s39, 0
s_mov_b32 s42, 0xffff0000
K2_BATCH:
s_sub_u32 s40, s37, s39
s_min_u32 s40, s40, 2048
s_waitcnt lgkmcnt(0)
s_barrier
s_mov_b32 s41, 0
K2_PB:
v_add_u32 v12, s41, v0
v_add_u32 v13, 512, v12
v_add_u32 v14, s39, v12
v_add_u32 v15, s39, v13
v_mov_b32 v16, 0
v_mov_b32 v17, 0
v_add_u32 v18, 128, v16
v_add_u32 v19, 128, v17
v_lshlrev_b32 v20, 2, v18
v_lshlrev_b32 v21, 2, v19
ds_read_b32 v20, v20 offset:1024
ds_read_b32 v21, v21 offset:1024
s_waitcnt lgkmcnt(1)
v_cmp_le_u32 vcc, v20, v14
s_waitcnt lgkmcnt(0)
v_cmp_le_u32 s[52:53], v21, v15
s_nop 1
v_cndmask_b32 v16, v16, v18, vcc
v_cndmask_b32 v17, v17, v19, s[52:53]
v_add_u32 v18, 64, v16
v_add_u32 v19, 64, v17
v_lshlrev_b32 v20, 2, v18
v_lshlrev_b32 v21, 2, v19
ds_read_b32 v20, v20 offset:1024
ds_read_b32 v21, v21 offset:1024
s_waitcnt lgkmcnt(1)
v_cmp_le_u32 vcc, v20, v14
s_waitcnt lgkmcnt(0)
v_cmp_le_u32 s[52:53], v21, v15
s_nop 1
v_cndmask_b32 v16, v16, v18, vcc
v_cndmask_b32 v17, v17, v19, s[52:53]
v_add_u32 v18, 32, v16
v_add_u32 v19, 32, v17
v_lshlrev_b32 v20, 2, v18
v_lshlrev_b32 v21, 2, v19
ds_read_b32 v20, v20 offset:1024
ds_read_b32 v21, v21 offset:1024
s_waitcnt lgkmcnt(1)
v_cmp_le_u32 vcc, v20, v14
s_waitcnt lgkmcnt(0)
v_cmp_le_u32 s[52:53], v21, v15
s_nop 1
v_cndmask_b32 v16, v16, v18, vcc
v_cndmask_b32 v17, v17, v19, s[52:53]
v_add_u32 v18, 16, v16
v_add_u32 v19, 16, v17
v_lshlrev_b32 v20, 2, v18
v_lshlrev_b32 v21, 2, v19
ds_read_b32 v20, v20 offset:1024
ds_read_b32 v21, v21 offset:1024
s_waitcnt lgkmcnt(1)
v_cmp_le_u32 vcc, v20, v14
s_waitcnt lgkmcnt(0)
v_cmp_le_u32 s[52:53], v21, v15
s_nop 1
v_cndmask_b32 v16, v16, v18, vcc
v_cndmask_b32 v17, v17, v19, s[52:53]
v_add_u32 v18, 8, v16
v_add_u32 v19, 8, v17
v_lshlrev_b32 v20, 2, v18
v_lshlrev_b32 v21, 2, v19
ds_read_b32 v20, v20 offset:1024
ds_read_b32 v21, v21 offset:1024
s_waitcnt lgkmcnt(1)
v_cmp_le_u32 vcc, v20, v14
s_waitcnt lgkmcnt(0)
v_cmp_le_u32 s[52:53], v21, v15
s_nop 1
v_cndmask_b32 v16, v16, v18, vcc
v_cndmask_b32 v17, v17, v19, s[52:53]
v_add_u32 v18, 4, v16
v_add_u32 v19, 4, v17
v_lshlrev_b32 v20, 2, v18
v_lshlrev_b32 v21, 2, v19
ds_read_b32 v20, v20 offset:1024
ds_read_b32 v21, v21 offset:1024
s_waitcnt lgkmcnt(1)
v_cmp_le_u32 vcc, v20, v14
s_waitcnt lgkmcnt(0)
v_cmp_le_u32 s[52:53], v21, v15
s_nop 1
v_cndmask_b32 v16, v16, v18, vcc
v_cndmask_b32 v17, v17, v19, s[52:53]
v_add_u32 v18, 2, v16
v_add_u32 v19, 2, v17
v_lshlrev_b32 v20, 2, v18
v_lshlrev_b32 v21, 2, v19
ds_read_b32 v20, v20 offset:1024
ds_read_b32 v21, v21 offset:1024
s_waitcnt lgkmcnt(1)
v_cmp_le_u32 vcc, v20, v14
s_waitcnt lgkmcnt(0)
v_cmp_le_u32 s[52:53], v21, v15
s_nop 1
v_cndmask_b32 v16, v16, v18, vcc
v_cndmask_b32 v17, v17, v19, s[52:53]
v_add_u32 v18, 1, v16
v_add_u32 v19, 1, v17
v_lshlrev_b32 v20, 2, v18
v_lshlrev_b32 v21, 2, v19
ds_read_b32 v20, v20 offset:1024
ds_read_b32 v21, v21 offset:1024
s_waitcnt lgkmcnt(1)
v_cmp_le_u32 vcc, v20, v14
s_waitcnt lgkmcnt(0)
v_cmp_le_u32 s[52:53], v21, v15
s_nop 1
v_cndmask_b32 v16, v16, v18, vcc
v_cndmask_b32 v17, v17, v19, s[52:53]
v_lshlrev_b32 v20, 2, v16
v_lshlrev_b32 v21, 2, v17
ds_read_b32 v20, v20 offset:2048
ds_read_b32 v21, v21 offset:2048
v_cmp_gt_u32 s[52:53], s40, v12
v_cmp_gt_u32 s[54:55], s40, v13
v_mov_b32 v22, 0x7ffffff0
s_waitcnt lgkmcnt(0)
v_add_u32 v20, v20, v14
v_add_u32 v21, v21, v15
v_lshlrev_b32 v20, 3, v20
v_lshlrev_b32 v21, 3, v21
v_cndmask_b32 v20, v22, v20, s[52:53]
v_cndmask_b32 v21, v22, v21, s[54:55]
buffer_load_dwordx2 v[24:25], v20, s[16:19], 0 offen
buffer_load_dwordx2 v[26:27], v21, s[16:19], 0 offen
v_mov_b32 v23, 1
s_mov_b64 s[56:57], exec
s_waitcnt vmcnt(1)
v_lshlrev_b32 v28, 2, v25
s_mov_b64 exec, s[52:53]
ds_add_rtn_u32 v30, v28, v23 offset:0
s_mov_b64 exec, s[56:57]
s_waitcnt vmcnt(0)
v_lshlrev_b32 v29, 2, v27
s_mov_b64 exec, s[54:55]
ds_add_rtn_u32 v31, v29, v23 offset:0
s_mov_b64 exec, s[56:57]
v_lshlrev_b32 v28, 3, v12
v_lshlrev_b32 v29, 3, v13
s_waitcnt lgkmcnt(0)
v_lshl_or_b32 v25, v30, 6, v25
v_lshl_or_b32 v27, v31, 6, v27
s_mov_b64 exec, s[52:53]
ds_write_b64 v28, v[24:25] offset:3072
s_mov_b64 exec, s[54:55]
ds_write_b64 v29, v[26:27] offset:3072
s_mov_b64 exec, s[56:57]
s_add_u32 s41, s41, 1024
s_cmp_lt_u32 s41, s40
s_cbranch_scc1 K2_PB
s_waitcnt lgkmcnt(0)
s_barrier
s_cmp_lg_u32 s25, 0
s_cbranch_scc1 K2_SCAN_DONE
v_lshlrev_b32 v12, 2, v1
ds_read_b32 v13, v12 offset:0
s_waitcnt lgkmcnt(0)
v_mov_b32 v14, v13
s_nop 1
v_add_u32_dpp v14, v14, v14 row_shr:1 row_mask:0xf bank_mask:0xf bound_ctrl:0
s_nop 1
v_add_u32_dpp v14, v14, v14 row_shr:2 row_mask:0xf bank_mask:0xf bound_ctrl:0
s_nop 1
v_add_u32_dpp v14, v14, v14 row_shr:4 row_mask:0xf bank_mask:0xf bound_ctrl:0
s_nop 1
v_add_u32_dpp v14, v14, v14 row_shr:8 row_mask:0xf bank_mask:0xf bound_ctrl:0
s_nop 1
v_add_u32_dpp v14, v14, v14 row_bcast:15 row_mask:0xa bank_mask:0xf
s_nop 1
v_add_u32_dpp v14, v14, v14 row_bcast:31 row_mask:0xc bank_mask:0xf
s_nop 1
v_sub_u32 v14, v14, v13
ds_write_b32 v12, v14 offset:256
s_waitcnt lgkmcnt(0)
K2_SCAN_DONE:
s_barrier
s_mov_b32 s41, 0
K2_PC:
v_add_u32 v12, s41, v0
v_add_u32 v13, 512, v12
v_cmp_gt_u32 s[52:53], s40, v12
v_cmp_gt_u32 s[54:55], s40, v13
v_lshlrev_b32 v14, 3, v12
v_lshlrev_b32 v15, 3, v13
ds_read_b64 v[16:17], v14 offset:3072
ds_read_b64 v[18:19], v15 offset:3072
s_waitcnt lgkmcnt(0)
v_and_b32 v20, 63, v17
v_and_b32 v21, 63, v19
v_lshlrev_b32 v20, 2, v20
v_lshlrev_b32 v21, 2, v21
ds_read_b32 v20, v20 offset:256
ds_read_b32 v21, v21 offset:256
v_lshrrev_b32 v17, 6, v17
v_lshrrev_b32 v19, 6, v19
s_waitcnt lgkmcnt(0)
v_add_u32 v20, v20, v17
v_add_u32 v21, v21, v19
v_lshlrev_b32 v20, 2, v20
v_lshlrev_b32 v21, 2, v21
s_mov_b64 exec, s[52:53]
ds_write_b32 v20, v16 offset:19456
s_mov_b64 exec, s[54:55]
ds_write_b32 v21, v18 offset:19456
s_mov_b64 exec, s[56:57]
s_add_u32 s41, s41, 1024
s_cmp_lt_u32 s41, s40
s_cbranch_scc1 K2_PC
s_waitcnt lgkmcnt(0)
s_barrier
v_lshlrev_b32 v12, 2, v3
ds_read_b32 v13, v12 offset:256
ds_read_b32 v14, v12 offset:0
v_lshlrev_b32 v15, 4, v4
v_mov_b32 v16, 0
v_mov_b32 v17, 0x7ffffff0
s_waitcnt lgkmcnt(0)
v_lshlrev_b32 v13, 2, v13
K2_PD:
v_add_u32 v18, 0, v16
v_lshl_add_u32 v19, v18, 2, v13
ds_read_b32 v24, v19 offset:19456
v_add_u32 v18, 1, v16
v_lshl_add_u32 v19, v18, 2, v13
ds_read_b32 v25, v19 offset:19456
v_add_u32 v18, 2, v16
v_lshl_add_u32 v19, v18, 2, v13
ds_read_b32 v26, v19 offset:19456
v_add_u32 v18, 3, v16
v_lshl_add_u32 v19, v18, 2, v13
ds_read_b32 v27, v19 offset:19456
s_waitcnt lgkmcnt(0)
v_add_u32 v18, 0, v16
v_cmp_lt_u32 vcc, v18, v14
v_and_b32 v19, 0xffff, v24
v_lshl_add_u32 v19, v19, 7, v15
v_cndmask_b32 v19, v17, v19, vcc
v_cndmask_b32 v24, 0, v24, vcc
buffer_load_dwordx4 v[48:51], v19, s[12:15], 0 offen
v_lshrrev_b32 v28, 16, v24
v_and_b32 v24, s42, v24
v_add_u32 v18, 1, v16
v_cmp_lt_u32 vcc, v18, v14
v_and_b32 v19, 0xffff, v25
v_lshl_add_u32 v19, v19, 7, v15
v_cndmask_b32 v19, v17, v19, vcc
v_cndmask_b32 v25, 0, v25, vcc
buffer_load_dwordx4 v[52:55], v19, s[12:15], 0 offen
v_lshrrev_b32 v29, 16, v25
v_and_b32 v25, s42, v25
v_add_u32 v18, 2, v16
v_cmp_lt_u32 vcc, v18, v14
v_and_b32 v19, 0xffff, v26
v_lshl_add_u32 v19, v19, 7, v15
v_cndmask_b32 v19, v17, v19, vcc
v_cndmask_b32 v26, 0, v26, vcc
buffer_load_dwordx4 v[56:59], v19, s[12:15], 0 offen
v_lshrrev_b32 v30, 16, v26
v_and_b32 v26, s42, v26
v_add_u32 v18, 3, v16
v_cmp_lt_u32 vcc, v18, v14
v_and_b32 v19, 0xffff, v27
v_lshl_add_u32 v19, v19, 7, v15
v_cndmask_b32 v19, v17, v19, vcc
v_cndmask_b32 v27, 0, v27, vcc
buffer_load_dwordx4 v[60:63], v19, s[12:15], 0 offen
v_lshrrev_b32 v31, 16, v27
v_and_b32 v27, s42, v27
s_waitcnt vmcnt(3)
v_dot2_f32_bf16 v40, v48, v28, v40
v_dot2_f32_bf16 v41, v48, v24, v41
v_dot2_f32_bf16 v42, v49, v28, v42
v_dot2_f32_bf16 v43, v49, v24, v43
v_dot2_f32_bf16 v44, v50, v28, v44
v_dot2_f32_bf16 v45, v50, v24, v45
v_dot2_f32_bf16 v46, v51, v28, v46
v_dot2_f32_bf16 v47, v51, v24, v47
s_waitcnt vmcnt(2)
v_dot2_f32_bf16 v40, v52, v29, v40
v_dot2_f32_bf16 v41, v52, v25, v41
v_dot2_f32_bf16 v42, v53, v29, v42
v_dot2_f32_bf16 v43, v53, v25, v43
v_dot2_f32_bf16 v44, v54, v29, v44
v_dot2_f32_bf16 v45, v54, v25, v45
v_dot2_f32_bf16 v46, v55, v29, v46
v_dot2_f32_bf16 v47, v55, v25, v47
s_waitcnt vmcnt(1)
v_dot2_f32_bf16 v40, v56, v30, v40
v_dot2_f32_bf16 v41, v56, v26, v41
v_dot2_f32_bf16 v42, v57, v30, v42
v_dot2_f32_bf16 v43, v57, v26, v43
v_dot2_f32_bf16 v44, v58, v30, v44
v_dot2_f32_bf16 v45, v58, v26, v45
v_dot2_f32_bf16 v46, v59, v30, v46
v_dot2_f32_bf16 v47, v59, v26, v47
s_waitcnt vmcnt(0)
v_dot2_f32_bf16 v40, v60, v31, v40
v_dot2_f32_bf16 v41, v60, v27, v41
v_dot2_f32_bf16 v42, v61, v31, v42
v_dot2_f32_bf16 v43, v61, v27, v43
v_dot2_f32_bf16 v44, v62, v31, v44
v_dot2_f32_bf16 v45, v62, v27, v45
v_dot2_f32_bf16 v46, v63, v31, v46
v_dot2_f32_bf16 v47, v63, v27, v47
v_add_u32 v16, 4, v16
v_cmp_lt_u32 vcc, v16, v14
s_nop 4
s_cbranch_vccnz K2_PD
K2_NOD:
s_add_u32 s39, s39, 2048
s_cmp_lt_u32 s39, s37
s_cbranch_scc0 K2_OUT
s_barrier
v_mov_b32 v13, 0
v_cmp_gt_u32 vcc, 64, v0
s_and_saveexec_b64 s[26:27], vcc
ds_write_b32 v11, v13 offset:0
s_mov_b64 exec, s[26:27]
s_branch K2_BATCH
K2_OUT:
s_barrier
v_mul_u32_u24 v12, 272, v3
v_lshl_add_u32 v12, v4, 5, v12
ds_write_b32 v12, v40 offset:3072
ds_write_b32 v12, v41 offset:3076
ds_write_b32 v12, v42 offset:3080
ds_write_b32 v12, v43 offset:3084
ds_write_b32 v12, v44 offset:3088
ds_write_b32 v12, v45 offset:3092
ds_write_b32 v12, v46 offset:3096
ds_write_b32 v12, v47 offset:3100
s_waitcnt lgkmcnt(0)
s_barrier
s_cmp_gt_u32 s25, 3
s_cbranch_scc1 K2_END
s_and_b32 s26, s25, 1
s_lshr_b32 s27, s25, 1
v_and_b32 v12, 31, v1
v_lshrrev_b32 v13, 5, v1
s_lshl_b32 s28, s26, 5
v_add_u32 v14, s28, v12
v_mul_u32_u24 v14, 144, v14
v_lshl_add_u32 v14, v13, 4, v14
s_lshl_b32 s29, s27, 5
v_add_u32 v15, s29, v12
v_mul_u32_u24 v15, 272, v15
v_lshl_add_u32 v15, v13, 5, v15
ds_read_b128 v[32:35], v14 offset:27648
ds_read_b128 v[36:39], v15 offset:3072
ds_read_b128 v[40:43], v15 offset:3088
s_waitcnt lgkmcnt(0)
v_cvt_pk_bf16_f32 v44, v36, v37
v_cvt_pk_bf16_f32 v45, v38, v39
v_cvt_pk_bf16_f32 v46, v40, v41
v_cvt_pk_bf16_f32 v47, v42, v43
v_lshlrev_b32 v48, 16, v44
v_and_b32 v49, s42, v44
v_sub_f32 v36, v36, v48
v_sub_f32 v37, v37, v49
v_lshlrev_b32 v48, 16, v45
v_and_b32 v49, s42, v45
v_sub_f32 v38, v38, v48
v_sub_f32 v39, v39, v49
v_lshlrev_b32 v48, 16, v46
v_and_b32 v49, s42, v46
v_sub_f32 v40, v40, v48
v_sub_f32 v41, v41, v49
v_lshlrev_b32 v48, 16, v47
v_and_b32 v49, s42, v47
v_sub_f32 v42, v42, v48
v_sub_f32 v43, v43, v49
v_cvt_pk_bf16_f32 v36, v36, v37
v_cvt_pk_bf16_f32 v37, v38, v39
v_cvt_pk_bf16_f32 v38, v40, v41
v_cvt_pk_bf16_f32 v39, v42, v43
s_nop 1
v_mfma_f32_32x32x16_bf16 v[16:31], v[32:35], v[44:47], 0
v_mfma_f32_32x32x16_bf16 v[16:31], v[32:35], v[36:39], v[16:31]
ds_read_b128 v[32:35], v14 offset:27680
ds_read_b128 v[36:39], v15 offset:3136
ds_read_b128 v[40:43], v15 offset:3152
s_waitcnt lgkmcnt(0)
v_cvt_pk_bf16_f32 v44, v36, v37
v_cvt_pk_bf16_f32 v45, v38, v39
v_cvt_pk_bf16_f32 v46, v40, v41
v_cvt_pk_bf16_f32 v47, v42, v43
v_lshlrev_b32 v48, 16, v44
v_and_b32 v49, s42, v44
v_sub_f32 v36, v36, v48
v_sub_f32 v37, v37, v49
v_lshlrev_b32 v48, 16, v45
v_and_b32 v49, s42, v45
v_sub_f32 v38, v38, v48
v_sub_f32 v39, v39, v49
v_lshlrev_b32 v48, 16, v46
v_and_b32 v49, s42, v46
v_sub_f32 v40, v40, v48
v_sub_f32 v41, v41, v49
v_lshlrev_b32 v48, 16, v47
v_and_b32 v49, s42, v47
v_sub_f32 v42, v42, v48
v_sub_f32 v43, v43, v49
v_cvt_pk_bf16_f32 v36, v36, v37
v_cvt_pk_bf16_f32 v37, v38, v39
v_cvt_pk_bf16_f32 v38, v40, v41
v_cvt_pk_bf16_f32 v39, v42, v43
s_nop 1
v_mfma_f32_32x32x16_bf16 v[16:31], v[32:35], v[44:47], v[16:31]
v_mfma_f32_32x32x16_bf16 v[16:31], v[32:35], v[36:39], v[16:31]
ds_read_b128 v[32:35], v14 offset:27712
ds_read_b128 v[36:39], v15 offset:3200
ds_read_b128 v[40:43], v15 offset:3216
s_waitcnt lgkmcnt(0)
v_cvt_pk_bf16_f32 v44, v36, v37
v_cvt_pk_bf16_f32 v45, v38, v39
v_cvt_pk_bf16_f32 v46, v40, v41
v_cvt_pk_bf16_f32 v47, v42, v43
v_lshlrev_b32 v48, 16, v44
v_and_b32 v49, s42, v44
v_sub_f32 v36, v36, v48
v_sub_f32 v37, v37, v49
v_lshlrev_b32 v48, 16, v45
v_and_b32 v49, s42, v45
v_sub_f32 v38, v38, v48
v_sub_f32 v39, v39, v49
v_lshlrev_b32 v48, 16, v46
v_and_b32 v49, s42, v46
v_sub_f32 v40, v40, v48
v_sub_f32 v41, v41, v49
v_lshlrev_b32 v48, 16, v47
v_and_b32 v49, s42, v47
v_sub_f32 v42, v42, v48
v_sub_f32 v43, v43, v49
v_cvt_pk_bf16_f32 v36, v36, v37
v_cvt_pk_bf16_f32 v37, v38, v39
v_cvt_pk_bf16_f32 v38, v40, v41
v_cvt_pk_bf16_f32 v39, v42, v43
s_nop 1
v_mfma_f32_32x32x16_bf16 v[16:31], v[32:35], v[44:47], v[16:31]
v_mfma_f32_32x32x16_bf16 v[16:31], v[32:35], v[36:39], v[16:31]
ds_read_b128 v[32:35], v14 offset:27744
ds_read_b128 v[36:39], v15 offset:3264
ds_read_b128 v[40:43], v15 offset:3280
s_waitcnt lgkmcnt(0)
v_cvt_pk_bf16_f32 v44, v36, v37
v_cvt_pk_bf16_f32 v45, v38, v39
v_cvt_pk_bf16_f32 v46, v40, v41
v_cvt_pk_bf16_f32 v47, v42, v43
v_lshlrev_b32 v48, 16, v44
v_and_b32 v49, s42, v44
v_sub_f32 v36, v36, v48
v_sub_f32 v37, v37, v49
v_lshlrev_b32 v48, 16, v45
v_and_b32 v49, s42, v45
v_sub_f32 v38, v38, v48
v_sub_f32 v39, v39, v49
v_lshlrev_b32 v48, 16, v46
v_and_b32 v49, s42, v46
v_sub_f32 v40, v40, v48
v_sub_f32 v41, v41, v49
v_lshlrev_b32 v48, 16, v47
v_and_b32 v49, s42, v47
v_sub_f32 v42, v42, v48
v_sub_f32 v43, v43, v49
v_cvt_pk_bf16_f32 v36, v36, v37
v_cvt_pk_bf16_f32 v37, v38, v39
v_cvt_pk_bf16_f32 v38, v40, v41
v_cvt_pk_bf16_f32 v39, v42, v43
s_nop 1
v_mfma_f32_32x32x16_bf16 v[16:31], v[32:35], v[44:47], v[16:31]
v_mfma_f32_32x32x16_bf16 v[16:31], v[32:35], v[36:39], v[16:31]
s_nop 15
s_nop 7
s_lshl_b32 s30, s2, 13
s_lshl_b32 s31, s27, 12
s_add_u32 s30, s30, s31
s_lshl_b32 s31, s26, 6
s_add_u32 s30, s30, s31
v_lshlrev_b32 v12, 7, v12
v_lshl_add_u32 v12, v13, 3, v12
v_cvt_pk_bf16_f32 v40, v16, v17
v_cvt_pk_bf16_f32 v41, v18, v19
buffer_store_dwordx2 v[40:41], v12, s[8:11], s30 offen offset:0
v_cvt_pk_bf16_f32 v42, v20, v21
v_cvt_pk_bf16_f32 v43, v22, v23
buffer_store_dwordx2 v[42:43], v12, s[8:11], s30 offen offset:16
v_cvt_pk_bf16_f32 v44, v24, v25
v_cvt_pk_bf16_f32 v45, v26, v27
buffer_store_dwordx2 v[44:45], v12, s[8:11], s30 offen offset:32
v_cvt_pk_bf16_f32 v46, v28, v29
v_cvt_pk_bf16_f32 v47, v30, v31
buffer_store_dwordx2 v[46:47], v12, s[8:11], s30 offen offset:48
K2_END:
s_endpgm
.section .rodata,"a"
.p2align 6
.amdhsa_kernel spmm_k1_kernel
  .amdhsa_next_free_vgpr 96
  .amdhsa_next_free_sgpr 64
  .amdhsa_accum_offset 96
  .amdhsa_group_segment_fixed_size 0
  .amdhsa_kernarg_size 64
  .amdhsa_user_sgpr_count 2
  .amdhsa_user_sgpr_kernarg_segment_ptr 1
  .amdhsa_system_sgpr_workgroup_id_x 1
.end_amdhsa_kernel
.section .rodata,"a"
.p2align 6
.amdhsa_kernel spmm_k2_kernel
  .amdhsa_next_free_vgpr 64
  .amdhsa_next_free_sgpr 64
  .amdhsa_accum_offset 64
  .amdhsa_group_segment_fixed_size 0
  .amdhsa_kernarg_size 64
  .amdhsa_user_sgpr_count 2
  .amdhsa_user_sgpr_kernarg_segment_ptr 1
  .amdhsa_system_sgpr_workgroup_id_x 1
.end_amdhsa_kernel
```

```asm
; @launch kernel=spmm_k1_kernel grid=(392,1,1) block=(256,1,1) lds=37120
; @launch kernel=spmm_k2_kernel grid=(782,1,1) block=(512,1,1) lds=28672
.amdgcn_target "amdgcn-amd-amdhsa--gfx950"
.text
.globl spmm_k1_kernel
.p2align 8
.type spmm_k1_kernel,@function
spmm_k1_kernel:
s_cmp_ge_u32 s2, 392
s_cbranch_scc1 K1_END
s_load_dwordx4 s[4:7], s[0:1], 0
s_load_dwordx4 s[8:11], s[0:1], 16
s_load_dwordx2 s[12:13], s[0:1], 32
s_load_dwordx2 s[14:15], s[0:1], 56
s_waitcnt lgkmcnt(0)
s_cmp_ge_u32 s2, 196
s_cbranch_scc1 K1_GEMM
s_mov_b32 s16, s8
s_mov_b32 s17, s9
s_mov_b32 s18, 0x30d400
s_mov_b32 s19, 0x00020000
s_mov_b32 s20, s6
s_mov_b32 s21, s7
s_mov_b32 s22, 0x30d400
s_mov_b32 s23, 0x00020000
s_mov_b32 s24, s10
s_mov_b32 s25, s11
s_mov_b32 s26, 0x186a00
s_mov_b32 s27, 0x00020000
s_add_u32 s28, s14, 0x800000
s_addc_u32 s29, s15, 0
s_mov_b32 s30, 0x620000
s_mov_b32 s31, 0x00020000
s_add_u32 s32, s14, 0x1000000
s_addc_u32 s33, s15, 0
s_mov_b32 s34, 0xc4000
s_mov_b32 s35, 0x00020000
s_lshl_b32 s36, s2, 12
v_lshlrev_b32 v1, 2, v0
v_add_u32 v1, s36, v1
v_lshlrev_b32 v2, 2, v1
v_lshlrev_b32 v3, 1, v1
v_mov_b32 v4, 0
v_mov_b32 v5, 0
v_mov_b32 v6, 0
v_mov_b32 v7, 0
v_lshlrev_b32 v8, 4, v0
ds_write_b128 v8, v[4:7] offset:0
s_mov_b32 s37, 4096
s_mov_b32 s38, 8192
s_mov_b32 s39, 12288
s_mov_b32 s40, 2048
s_mov_b32 s41, 4096
s_mov_b32 s42, 6144
buffer_load_dwordx4 v[12:15], v2, s[16:19], 0 offen
buffer_load_dwordx4 v[16:19], v2, s[16:19], s37 offen
buffer_load_dwordx4 v[20:23], v2, s[16:19], s38 offen
buffer_load_dwordx4 v[24:27], v2, s[16:19], s39 offen
buffer_load_dwordx4 v[28:31], v2, s[20:23], 0 offen
buffer_load_dwordx4 v[32:35], v2, s[20:23], s37 offen
buffer_load_dwordx4 v[36:39], v2, s[20:23], s38 offen
buffer_load_dwordx4 v[40:43], v2, s[20:23], s39 offen
buffer_load_dwordx2 v[44:45], v3, s[24:27], 0 offen
buffer_load_dwordx2 v[46:47], v3, s[24:27], s40 offen
buffer_load_dwordx2 v[48:49], v3, s[24:27], s41 offen
buffer_load_dwordx2 v[50:51], v3, s[24:27], s42 offen
s_mov_b32 s43, 0xffff0000
v_mov_b32 v9, 1
v_mov_b32 v10, 1023
s_waitcnt lgkmcnt(0)
s_barrier
s_waitcnt vmcnt(0)
v_add_u32 v11, 0, v1
v_cmp_gt_u32 vcc, 800000, v11
v_lshrrev_b32 v52, 6, v12
v_and_b32 v12, 63, v12
v_cndmask_b32 v52, v10, v52, vcc
v_lshlrev_b32 v52, 2, v52
v_lshl_or_b32 v28, v44, 16, v28
ds_add_rtn_u32 v68, v52, v9 offset:0
v_lshrrev_b32 v53, 6, v13
v_and_b32 v13, 63, v13
v_cndmask_b32 v53, v10, v53, vcc
v_lshlrev_b32 v53, 2, v53
v_and_or_b32 v29, v44, s43, v29
ds_add_rtn_u32 v69, v53, v9 offset:0
v_lshrrev_b32 v54, 6, v14
v_and_b32 v14, 63, v14
v_cndmask_b32 v54, v10, v54, vcc
v_lshlrev_b32 v54, 2, v54
v_lshl_or_b32 v30, v45, 16, v30
ds_add_rtn_u32 v70, v54, v9 offset:0
v_lshrrev_b32 v55, 6, v15
v_and_b32 v15, 63, v15
v_cndmask_b32 v55, v10, v55, vcc
v_lshlrev_b32 v55, 2, v55
v_and_or_b32 v31, v45, s43, v31
ds_add_rtn_u32 v71, v55, v9 offset:0
v_add_u32 v11, 1024, v1
v_cmp_gt_u32 vcc, 800000, v11
v_lshrrev_b32 v56, 6, v16
v_and_b32 v16, 63, v16
v_cndmask_b32 v56, v10, v56, vcc
v_lshlrev_b32 v56, 2, v56
v_lshl_or_b32 v32, v46, 16, v32
ds_add_rtn_u32 v72, v56, v9 offset:0
v_lshrrev_b32 v57, 6, v17
v_and_b32 v17, 63, v17
v_cndmask_b32 v57, v10, v57, vcc
v_lshlrev_b32 v57, 2, v57
v_and_or_b32 v33, v46, s43, v33
ds_add_rtn_u32 v73, v57, v9 offset:0
v_lshrrev_b32 v58, 6, v18
v_and_b32 v18, 63, v18
v_cndmask_b32 v58, v10, v58, vcc
v_lshlrev_b32 v58, 2, v58
v_lshl_or_b32 v34, v47, 16, v34
ds_add_rtn_u32 v74, v58, v9 offset:0
v_lshrrev_b32 v59, 6, v19
v_and_b32 v19, 63, v19
v_cndmask_b32 v59, v10, v59, vcc
v_lshlrev_b32 v59, 2, v59
v_and_or_b32 v35, v47, s43, v35
ds_add_rtn_u32 v75, v59, v9 offset:0
v_add_u32 v11, 2048, v1
v_cmp_gt_u32 vcc, 800000, v11
v_lshrrev_b32 v60, 6, v20
v_and_b32 v20, 63, v20
v_cndmask_b32 v60, v10, v60, vcc
v_lshlrev_b32 v60, 2, v60
v_lshl_or_b32 v36, v48, 16, v36
ds_add_rtn_u32 v76, v60, v9 offset:0
v_lshrrev_b32 v61, 6, v21
v_and_b32 v21, 63, v21
v_cndmask_b32 v61, v10, v61, vcc
v_lshlrev_b32 v61, 2, v61
v_and_or_b32 v37, v48, s43, v37
ds_add_rtn_u32 v77, v61, v9 offset:0
v_lshrrev_b32 v62, 6, v22
v_and_b32 v22, 63, v22
v_cndmask_b32 v62, v10, v62, vcc
v_lshlrev_b32 v62, 2, v62
v_lshl_or_b32 v38, v49, 16, v38
ds_add_rtn_u32 v78, v62, v9 offset:0
v_lshrrev_b32 v63, 6, v23
v_and_b32 v23, 63, v23
v_cndmask_b32 v63, v10, v63, vcc
v_lshlrev_b32 v63, 2, v63
v_and_or_b32 v39, v49, s43, v39
ds_add_rtn_u32 v79, v63, v9 offset:0
v_add_u32 v11, 3072, v1
v_cmp_gt_u32 vcc, 800000, v11
v_lshrrev_b32 v64, 6, v24
v_and_b32 v24, 63, v24
v_cndmask_b32 v64, v10, v64, vcc
v_lshlrev_b32 v64, 2, v64
v_lshl_or_b32 v40, v50, 16, v40
ds_add_rtn_u32 v80, v64, v9 offset:0
v_lshrrev_b32 v65, 6, v25
v_and_b32 v25, 63, v25
v_cndmask_b32 v65, v10, v65, vcc
v_lshlrev_b32 v65, 2, v65
v_and_or_b32 v41, v50, s43, v41
ds_add_rtn_u32 v81, v65, v9 offset:0
v_lshrrev_b32 v66, 6, v26
v_and_b32 v26, 63, v26
v_cndmask_b32 v66, v10, v66, vcc
v_lshlrev_b32 v66, 2, v66
v_lshl_or_b32 v42, v51, 16, v42
ds_add_rtn_u32 v82, v66, v9 offset:0
v_lshrrev_b32 v67, 6, v27
v_and_b32 v27, 63, v27
v_cndmask_b32 v67, v10, v67, vcc
v_lshlrev_b32 v67, 2, v67
v_and_or_b32 v43, v51, s43, v43
ds_add_rtn_u32 v83, v67, v9 offset:0
s_waitcnt lgkmcnt(0)
s_barrier
ds_read_b128 v[4:7], v8 offset:0
s_waitcnt lgkmcnt(0)
v_add_u32 v11, v4, v5
v_add_u32 v11, v11, v6
v_add_u32 v11, v11, v7
v_mov_b32 v84, v11
s_nop 1
v_add_u32_dpp v84, v84, v84 row_shr:1 row_mask:0xf bank_mask:0xf bound_ctrl:0
s_nop 1
v_add_u32_dpp v84, v84, v84 row_shr:2 row_mask:0xf bank_mask:0xf bound_ctrl:0
s_nop 1
v_add_u32_dpp v84, v84, v84 row_shr:4 row_mask:0xf bank_mask:0xf bound_ctrl:0
s_nop 1
v_add_u32_dpp v84, v84, v84 row_shr:8 row_mask:0xf bank_mask:0xf bound_ctrl:0
s_nop 1
v_add_u32_dpp v84, v84, v84 row_bcast:15 row_mask:0xa bank_mask:0xf
s_nop 1
v_add_u32_dpp v84, v84, v84 row_bcast:31 row_mask:0xc bank_mask:0xf
s_nop 1
v_and_b32 v85, 63, v0
v_lshrrev_b32 v86, 6, v0
v_lshlrev_b32 v87, 2, v86
v_cmp_eq_u32 vcc, 63, v85
s_and_saveexec_b64 s[44:45], vcc
ds_write_b32 v87, v84 offset:4096
s_mov_b64 exec, s[44:45]
s_waitcnt lgkmcnt(0)
s_barrier
v_mov_b32 v88, 0
ds_read_b128 v[88:91], v88 offset:4096
v_readfirstlane_b32 s46, v86
s_waitcnt lgkmcnt(0)
v_sub_u32 v84, v84, v11
s_cmp_gt_u32 s46, 0
s_cselect_b32 s47, 1, 0
v_mul_lo_u32 v92, v88, s47
v_add_u32 v84, v84, v92
s_cmp_gt_u32 s46, 1
s_cselect_b32 s47, 1, 0
v_mul_lo_u32 v92, v89, s47
v_add_u32 v84, v84, v92
s_cmp_gt_u32 s46, 2
s_cselect_b32 s47, 1, 0
v_mul_lo_u32 v92, v90, s47
v_add_u32 v84, v84, v92
v_mov_b32 v92, v84
v_add_u32 v93, v92, v4
v_add_u32 v94, v93, v5
v_add_u32 v95, v94, v6
ds_write_b128 v8, v[92:95] offset:0
s_lshl_b32 s47, s2, 12
buffer_store_dwordx4 v[92:95], v8, s[32:35], s47 offen
s_waitcnt lgkmcnt(0)
s_barrier
ds_read_b32 v52, v52 offset:0
ds_read_b32 v53, v53 offset:0
ds_read_b32 v54, v54 offset:0
ds_read_b32 v55, v55 offset:0
ds_read_b32 v56, v56 offset:0
ds_read_b32 v57, v57 offset:0
ds_read_b32 v58, v58 offset:0
ds_read_b32 v59, v59 offset:0
ds_read_b32 v60, v60 offset:0
ds_read_b32 v61, v61 offset:0
ds_read_b32 v62, v62 offset:0
ds_read_b32 v63, v63 offset:0
ds_read_b32 v64, v64 offset:0
ds_read_b32 v65, v65 offset:0
ds_read_b32 v66, v66 offset:0
ds_read_b32 v67, v67 offset:0
s_waitcnt lgkmcnt(0)
v_add_u32 v52, v52, v68
v_lshlrev_b32 v52, 3, v52
v_add_u32 v52, 4352, v52
ds_write2_b32 v52, v28, v12 offset0:0 offset1:1
v_add_u32 v53, v53, v69
v_lshlrev_b32 v53, 3, v53
v_add_u32 v53, 4352, v53
ds_write2_b32 v53, v29, v13 offset0:0 offset1:1
v_add_u32 v54, v54, v70
v_lshlrev_b32 v54, 3, v54
v_add_u32 v54, 4352, v54
ds_write2_b32 v54, v30, v14 offset0:0 offset1:1
v_add_u32 v55, v55, v71
v_lshlrev_b32 v55, 3, v55
v_add_u32 v55, 4352, v55
ds_write2_b32 v55, v31, v15 offset0:0 offset1:1
v_add_u32 v56, v56, v72
v_lshlrev_b32 v56, 3, v56
v_add_u32 v56, 4352, v56
ds_write2_b32 v56, v32, v16 offset0:0 offset1:1
v_add_u32 v57, v57, v73
v_lshlrev_b32 v57, 3, v57
v_add_u32 v57, 4352, v57
ds_write2_b32 v57, v33, v17 offset0:0 offset1:1
v_add_u32 v58, v58, v74
v_lshlrev_b32 v58, 3, v58
v_add_u32 v58, 4352, v58
ds_write2_b32 v58, v34, v18 offset0:0 offset1:1
v_add_u32 v59, v59, v75
v_lshlrev_b32 v59, 3, v59
v_add_u32 v59, 4352, v59
ds_write2_b32 v59, v35, v19 offset0:0 offset1:1
v_add_u32 v60, v60, v76
v_lshlrev_b32 v60, 3, v60
v_add_u32 v60, 4352, v60
ds_write2_b32 v60, v36, v20 offset0:0 offset1:1
v_add_u32 v61, v61, v77
v_lshlrev_b32 v61, 3, v61
v_add_u32 v61, 4352, v61
ds_write2_b32 v61, v37, v21 offset0:0 offset1:1
v_add_u32 v62, v62, v78
v_lshlrev_b32 v62, 3, v62
v_add_u32 v62, 4352, v62
ds_write2_b32 v62, v38, v22 offset0:0 offset1:1
v_add_u32 v63, v63, v79
v_lshlrev_b32 v63, 3, v63
v_add_u32 v63, 4352, v63
ds_write2_b32 v63, v39, v23 offset0:0 offset1:1
v_add_u32 v64, v64, v80
v_lshlrev_b32 v64, 3, v64
v_add_u32 v64, 4352, v64
ds_write2_b32 v64, v40, v24 offset0:0 offset1:1
v_add_u32 v65, v65, v81
v_lshlrev_b32 v65, 3, v65
v_add_u32 v65, 4352, v65
ds_write2_b32 v65, v41, v25 offset0:0 offset1:1
v_add_u32 v66, v66, v82
v_lshlrev_b32 v66, 3, v66
v_add_u32 v66, 4352, v66
ds_write2_b32 v66, v42, v26 offset0:0 offset1:1
v_add_u32 v67, v67, v83
v_lshlrev_b32 v67, 3, v67
v_add_u32 v67, 4352, v67
ds_write2_b32 v67, v43, v27 offset0:0 offset1:1
s_waitcnt lgkmcnt(0)
s_barrier
s_lshl_b32 s47, s2, 15
ds_read_b128 v[12:15], v8 offset:4352
ds_read_b128 v[16:19], v8 offset:8448
ds_read_b128 v[20:23], v8 offset:12544
ds_read_b128 v[24:27], v8 offset:16640
ds_read_b128 v[28:31], v8 offset:20736
ds_read_b128 v[32:35], v8 offset:24832
ds_read_b128 v[36:39], v8 offset:28928
ds_read_b128 v[40:43], v8 offset:33024
s_waitcnt lgkmcnt(7)
buffer_store_dwordx4 v[12:15], v8, s[28:31], s47 offen offset:0
s_waitcnt lgkmcnt(6)
s_add_u32 s48, s47, 4096
buffer_store_dwordx4 v[16:19], v8, s[28:31], s48 offen
s_waitcnt lgkmcnt(5)
s_add_u32 s48, s47, 8192
buffer_store_dwordx4 v[20:23], v8, s[28:31], s48 offen
s_waitcnt lgkmcnt(4)
s_add_u32 s48, s47, 12288
buffer_store_dwordx4 v[24:27], v8, s[28:31], s48 offen
s_waitcnt lgkmcnt(3)
s_add_u32 s48, s47, 16384
buffer_store_dwordx4 v[28:31], v8, s[28:31], s48 offen
s_waitcnt lgkmcnt(2)
s_add_u32 s48, s47, 20480
buffer_store_dwordx4 v[32:35], v8, s[28:31], s48 offen
s_waitcnt lgkmcnt(1)
s_add_u32 s48, s47, 24576
buffer_store_dwordx4 v[36:39], v8, s[28:31], s48 offen
s_waitcnt lgkmcnt(0)
s_add_u32 s48, s47, 28672
buffer_store_dwordx4 v[40:43], v8, s[28:31], s48 offen
s_endpgm
K1_GEMM_F:
s_add_u32 s2, s2, 196
K1_GEMM:
s_mov_b32 s16, s4
s_mov_b32 s17, s5
s_mov_b32 s18, 0x61a800
s_mov_b32 s19, 0x00020000
s_mov_b32 s20, s12
s_mov_b32 s21, s13
s_mov_b32 s22, 0x2000
s_mov_b32 s23, 0x00020000
s_mov_b32 s24, s14
s_mov_b32 s25, s15
s_mov_b32 s26, 0x61a800
s_mov_b32 s27, 0x00020000
s_sub_u32 s28, s2, 196
v_and_b32 v1, 31, v0
v_and_b32 v2, 63, v0
v_lshrrev_b32 v2, 5, v2
v_lshrrev_b32 v3, 6, v0
v_lshlrev_b32 v4, 10, v2
v_lshl_add_u32 v4, v1, 1, v4
s_mov_b32 s29, 4096
buffer_load_ushort v16, v4, s[20:23], 0 offen offset:0
buffer_load_ushort v48, v4, s[20:23], 0 offen offset:128
buffer_load_ushort v17, v4, s[20:23], 0 offen offset:256
buffer_load_ushort v49, v4, s[20:23], 0 offen offset:384
buffer_load_ushort v18, v4, s[20:23], 0 offen offset:512
buffer_load_ushort v50, v4, s[20:23], 0 offen offset:640
buffer_load_ushort v19, v4, s[20:23], 0 offen offset:768
buffer_load_ushort v51, v4, s[20:23], 0 offen offset:896
buffer_load_ushort v20, v4, s[20:23], 0 offen offset:2048
buffer_load_ushort v52, v4, s[20:23], 0 offen offset:2176
buffer_load_ushort v21, v4, s[20:23], 0 offen offset:2304
buffer_load_ushort v53, v4, s[20:23], 0 offen offset:2432
buffer_load_ushort v22, v4, s[20:23], 0 offen offset:2560
buffer_load_ushort v54, v4, s[20:23], 0 offen offset:2688
buffer_load_ushort v23, v4, s[20:23], 0 offen offset:2816
buffer_load_ushort v55, v4, s[20:23], 0 offen offset:2944
buffer_load_ushort v24, v4, s[20:23], s29 offen offset:0
buffer_load_ushort v56, v4, s[20:23], s29 offen offset:128
buffer_load_ushort v25, v4, s[20:23], s29 offen offset:256
buffer_load_ushort v57, v4, s[20:23], s29 offen offset:384
buffer_load_ushort v26, v4, s[20:23], s29 offen offset:512
buffer_load_ushort v58, v4, s[20:23], s29 offen offset:640
buffer_load_ushort v27, v4, s[20:23], s29 offen offset:768
buffer_load_ushort v59, v4, s[20:23], s29 offen offset:896
buffer_load_ushort v28, v4, s[20:23], s29 offen offset:2048
buffer_load_ushort v60, v4, s[20:23], s29 offen offset:2176
buffer_load_ushort v29, v4, s[20:23], s29 offen offset:2304
buffer_load_ushort v61, v4, s[20:23], s29 offen offset:2432
buffer_load_ushort v30, v4, s[20:23], s29 offen offset:2560
buffer_load_ushort v62, v4, s[20:23], s29 offen offset:2688
buffer_load_ushort v31, v4, s[20:23], s29 offen offset:2816
buffer_load_ushort v63, v4, s[20:23], s29 offen offset:2944
buffer_load_ushort v32, v4, s[20:23], 0 offen offset:64
buffer_load_ushort v64, v4, s[20:23], 0 offen offset:192
buffer_load_ushort v33, v4, s[20:23], 0 offen offset:320
buffer_load_ushort v65, v4, s[20:23], 0 offen offset:448
buffer_load_ushort v34, v4, s[20:23], 0 offen offset:576
buffer_load_ushort v66, v4, s[20:23], 0 offen offset:704
buffer_load_ushort v35, v4, s[20:23], 0 offen offset:832
buffer_load_ushort v67, v4, s[20:23], 0 offen offset:960
buffer_load_ushort v36, v4, s[20:23], 0 offen offset:2112
buffer_load_ushort v68, v4, s[20:23], 0 offen offset:2240
buffer_load_ushort v37, v4, s[20:23], 0 offen offset:2368
buffer_load_ushort v69, v4, s[20:23], 0 offen offset:2496
buffer_load_ushort v38, v4, s[20:23], 0 offen offset:2624
buffer_load_ushort v70, v4, s[20:23], 0 offen offset:2752
buffer_load_ushort v39, v4, s[20:23], 0 offen offset:2880
buffer_load_ushort v71, v4, s[20:23], 0 offen offset:3008
buffer_load_ushort v40, v4, s[20:23], s29 offen offset:64
buffer_load_ushort v72, v4, s[20:23], s29 offen offset:192
buffer_load_ushort v41, v4, s[20:23], s29 offen offset:320
buffer_load_ushort v73, v4, s[20:23], s29 offen offset:448
buffer_load_ushort v42, v4, s[20:23], s29 offen offset:576
buffer_load_ushort v74, v4, s[20:23], s29 offen offset:704
buffer_load_ushort v43, v4, s[20:23], s29 offen offset:832
buffer_load_ushort v75, v4, s[20:23], s29 offen offset:960
buffer_load_ushort v44, v4, s[20:23], s29 offen offset:2112
buffer_load_ushort v76, v4, s[20:23], s29 offen offset:2240
buffer_load_ushort v45, v4, s[20:23], s29 offen offset:2368
buffer_load_ushort v77, v4, s[20:23], s29 offen offset:2496
buffer_load_ushort v46, v4, s[20:23], s29 offen offset:2624
buffer_load_ushort v78, v4, s[20:23], s29 offen offset:2752
buffer_load_ushort v47, v4, s[20:23], s29 offen offset:2880
buffer_load_ushort v79, v4, s[20:23], s29 offen offset:3008
s_waitcnt vmcnt(0)
v_lshl_or_b32 v16, v48, 16, v16
v_lshl_or_b32 v17, v49, 16, v17
v_lshl_or_b32 v18, v50, 16, v18
v_lshl_or_b32 v19, v51, 16, v19
v_lshl_or_b32 v20, v52, 16, v20
v_lshl_or_b32 v21, v53, 16, v21
v_lshl_or_b32 v22, v54, 16, v22
v_lshl_or_b32 v23, v55, 16, v23
v_lshl_or_b32 v24, v56, 16, v24
v_lshl_or_b32 v25, v57, 16, v25
v_lshl_or_b32 v26, v58, 16, v26
v_lshl_or_b32 v27, v59, 16, v27
v_lshl_or_b32 v28, v60, 16, v28
v_lshl_or_b32 v29, v61, 16, v29
v_lshl_or_b32 v30, v62, 16, v30
v_lshl_or_b32 v31, v63, 16, v31
v_lshl_or_b32 v32, v64, 16, v32
v_lshl_or_b32 v33, v65, 16, v33
v_lshl_or_b32 v34, v66, 16, v34
v_lshl_or_b32 v35, v67, 16, v35
v_lshl_or_b32 v36, v68, 16, v36
v_lshl_or_b32 v37, v69, 16, v37
v_lshl_or_b32 v38, v70, 16, v38
v_lshl_or_b32 v39, v71, 16, v39
v_lshl_or_b32 v40, v72, 16, v40
v_lshl_or_b32 v41, v73, 16, v41
v_lshl_or_b32 v42, v74, 16, v42
v_lshl_or_b32 v43, v75, 16, v43
v_lshl_or_b32 v44, v76, 16, v44
v_lshl_or_b32 v45, v77, 16, v45
v_lshl_or_b32 v46, v78, 16, v46
v_lshl_or_b32 v47, v79, 16, v47
s_lshl_b32 s30, s28, 3
v_lshlrev_b32 v5, 1, v3
v_add_u32 v5, s30, v5
v_lshlrev_b32 v5, 5, v5
v_add_u32 v5, v5, v1
v_lshlrev_b32 v6, 7, v5
v_lshl_add_u32 v7, v2, 4, v6
v_lshl_add_u32 v8, v2, 3, v6
buffer_load_dwordx4 v[48:51], v7, s[16:19], 0 offen offset:0
buffer_load_dwordx4 v[52:55], v7, s[16:19], 0 offen offset:32
buffer_load_dwordx4 v[56:59], v7, s[16:19], 0 offen offset:64
buffer_load_dwordx4 v[60:63], v7, s[16:19], 0 offen offset:96
buffer_load_dwordx4 v[64:67], v7, s[16:19], s29 offen offset:0
buffer_load_dwordx4 v[68:71], v7, s[16:19], s29 offen offset:32
buffer_load_dwordx4 v[72:75], v7, s[16:19], s29 offen offset:64
buffer_load_dwordx4 v[76:79], v7, s[16:19], s29 offen offset:96
s_waitcnt vmcnt(0)
v_mfma_f32_32x32x16_bf16 v[80:95], v[16:19], v[48:51], 0
v_mfma_f32_32x32x16_bf16 v[80:95], v[20:23], v[52:55], v[80:95]
v_mfma_f32_32x32x16_bf16 v[80:95], v[24:27], v[56:59], v[80:95]
v_mfma_f32_32x32x16_bf16 v[80:95], v[28:31], v[60:63], v[80:95]
v_mfma_f32_32x32x16_bf16 v[96:111], v[32:35], v[48:51], 0
v_mfma_f32_32x32x16_bf16 v[96:111], v[36:39], v[52:55], v[96:111]
v_mfma_f32_32x32x16_bf16 v[96:111], v[40:43], v[56:59], v[96:111]
v_mfma_f32_32x32x16_bf16 v[96:111], v[44:47], v[60:63], v[96:111]
s_nop 7
s_nop 7
v_cvt_pk_bf16_f32 v10, v80, v81
v_cvt_pk_bf16_f32 v11, v82, v83
buffer_store_dwordx2 v[10:11], v8, s[24:27], 0 offen offset:0
s_nop 1
v_cvt_pk_bf16_f32 v10, v84, v85
v_cvt_pk_bf16_f32 v11, v86, v87
buffer_store_dwordx2 v[10:11], v8, s[24:27], 0 offen offset:16
s_nop 1
v_cvt_pk_bf16_f32 v10, v88, v89
v_cvt_pk_bf16_f32 v11, v90, v91
buffer_store_dwordx2 v[10:11], v8, s[24:27], 0 offen offset:32
s_nop 1
v_cvt_pk_bf16_f32 v10, v92, v93
v_cvt_pk_bf16_f32 v11, v94, v95
buffer_store_dwordx2 v[10:11], v8, s[24:27], 0 offen offset:48
s_nop 1
v_cvt_pk_bf16_f32 v10, v96, v97
v_cvt_pk_bf16_f32 v11, v98, v99
buffer_store_dwordx2 v[10:11], v8, s[24:27], 0 offen offset:64
s_nop 1
v_cvt_pk_bf16_f32 v10, v100, v101
v_cvt_pk_bf16_f32 v11, v102, v103
buffer_store_dwordx2 v[10:11], v8, s[24:27], 0 offen offset:80
s_nop 1
v_cvt_pk_bf16_f32 v10, v104, v105
v_cvt_pk_bf16_f32 v11, v106, v107
buffer_store_dwordx2 v[10:11], v8, s[24:27], 0 offen offset:96
s_nop 1
v_cvt_pk_bf16_f32 v10, v108, v109
v_cvt_pk_bf16_f32 v11, v110, v111
buffer_store_dwordx2 v[10:11], v8, s[24:27], 0 offen offset:112
s_nop 1
v_mfma_f32_32x32x16_bf16 v[80:95], v[16:19], v[64:67], 0
v_mfma_f32_32x32x16_bf16 v[80:95], v[20:23], v[68:71], v[80:95]
v_mfma_f32_32x32x16_bf16 v[80:95], v[24:27], v[72:75], v[80:95]
v_mfma_f32_32x32x16_bf16 v[80:95], v[28:31], v[76:79], v[80:95]
v_mfma_f32_32x32x16_bf16 v[96:111], v[32:35], v[64:67], 0
v_mfma_f32_32x32x16_bf16 v[96:111], v[36:39], v[68:71], v[96:111]
v_mfma_f32_32x32x16_bf16 v[96:111], v[40:43], v[72:75], v[96:111]
v_mfma_f32_32x32x16_bf16 v[96:111], v[44:47], v[76:79], v[96:111]
s_nop 7
s_nop 7
v_cvt_pk_bf16_f32 v10, v80, v81
v_cvt_pk_bf16_f32 v11, v82, v83
buffer_store_dwordx2 v[10:11], v8, s[24:27], s29 offen offset:0
s_nop 1
v_cvt_pk_bf16_f32 v10, v84, v85
v_cvt_pk_bf16_f32 v11, v86, v87
buffer_store_dwordx2 v[10:11], v8, s[24:27], s29 offen offset:16
s_nop 1
v_cvt_pk_bf16_f32 v10, v88, v89
v_cvt_pk_bf16_f32 v11, v90, v91
buffer_store_dwordx2 v[10:11], v8, s[24:27], s29 offen offset:32
s_nop 1
v_cvt_pk_bf16_f32 v10, v92, v93
v_cvt_pk_bf16_f32 v11, v94, v95
buffer_store_dwordx2 v[10:11], v8, s[24:27], s29 offen offset:48
s_nop 1
v_cvt_pk_bf16_f32 v10, v96, v97
v_cvt_pk_bf16_f32 v11, v98, v99
buffer_store_dwordx2 v[10:11], v8, s[24:27], s29 offen offset:64
s_nop 1
v_cvt_pk_bf16_f32 v10, v100, v101
v_cvt_pk_bf16_f32 v11, v102, v103
buffer_store_dwordx2 v[10:11], v8, s[24:27], s29 offen offset:80
s_nop 1
v_cvt_pk_bf16_f32 v10, v104, v105
v_cvt_pk_bf16_f32 v11, v106, v107
buffer_store_dwordx2 v[10:11], v8, s[24:27], s29 offen offset:96
s_nop 1
v_cvt_pk_bf16_f32 v10, v108, v109
v_cvt_pk_bf16_f32 v11, v110, v111
buffer_store_dwordx2 v[10:11], v8, s[24:27], s29 offen offset:112
s_nop 1
K1_END:
s_endpgm
.globl spmm_k2_kernel
.p2align 8
.type spmm_k2_kernel,@function
spmm_k2_kernel:
s_cmp_ge_u32 s2, 782
s_cbranch_scc1 K2_END
s_load_dwordx2 s[4:5], s[0:1], 40
s_load_dwordx2 s[6:7], s[0:1], 56
s_waitcnt lgkmcnt(0)
s_mov_b32 s8, s4
s_mov_b32 s9, s5
s_mov_b32 s10, 0x61a800
s_mov_b32 s11, 0x00020000
s_mov_b32 s12, s6
s_mov_b32 s13, s7
s_mov_b32 s14, 0x61a800
s_mov_b32 s15, 0x00020000
s_add_u32 s16, s6, 0x800000
s_addc_u32 s17, s7, 0
s_mov_b32 s18, 0x620000
s_mov_b32 s19, 0x00020000
s_add_u32 s20, s6, 0x1000000
s_addc_u32 s21, s7, 0
s_mov_b32 s22, 0xc4000
s_mov_b32 s23, 0x00020000
v_and_b32 v1, 63, v0
v_lshrrev_b32 v2, 6, v0
v_lshrrev_b32 v3, 3, v0
v_and_b32 v4, 7, v0
s_lshl_b32 s24, s2, 2
v_lshlrev_b32 v5, 12, v0
buffer_load_dwordx2 v[6:7], v5, s[20:23], s24 offen
v_readfirstlane_b32 s25, v2
s_waitcnt vmcnt(0)
v_sub_u32 v8, v7, v6
v_mov_b32 v9, v8
s_nop 1
v_add_u32_dpp v9, v9, v9 row_shr:1 row_mask:0xf bank_mask:0xf bound_ctrl:0
s_nop 1
v_add_u32_dpp v9, v9, v9 row_shr:2 row_mask:0xf bank_mask:0xf bound_ctrl:0
s_nop 1
v_add_u32_dpp v9, v9, v9 row_shr:4 row_mask:0xf bank_mask:0xf bound_ctrl:0
s_nop 1
v_add_u32_dpp v9, v9, v9 row_shr:8 row_mask:0xf bank_mask:0xf bound_ctrl:0
s_nop 1
v_add_u32_dpp v9, v9, v9 row_bcast:15 row_mask:0xa bank_mask:0xf
s_nop 1
v_add_u32_dpp v9, v9, v9 row_bcast:31 row_mask:0xc bank_mask:0xf
s_nop 1
v_lshlrev_b32 v10, 2, v2
v_cmp_eq_u32 vcc, 63, v1
s_and_saveexec_b64 s[26:27], vcc
ds_write_b32 v10, v9 offset:512
s_mov_b64 exec, s[26:27]
s_waitcnt lgkmcnt(0)
s_barrier
v_mov_b32 v10, 0
ds_read_b128 v[12:15], v10 offset:512
ds_read_b128 v[16:19], v10 offset:528
s_waitcnt lgkmcnt(0)
v_readfirstlane_b32 s28, v12
v_readfirstlane_b32 s29, v13
v_readfirstlane_b32 s30, v14
v_readfirstlane_b32 s31, v15
v_readfirstlane_b32 s32, v16
v_readfirstlane_b32 s33, v17
v_readfirstlane_b32 s34, v18
v_readfirstlane_b32 s35, v19
s_nop 4
s_mov_b32 s36, 0
s_mov_b32 s37, 0
s_cmp_gt_u32 s25, 0
s_cselect_b32 s38, s28, 0
s_add_u32 s36, s36, s38
s_add_u32 s37, s37, s28
s_cmp_gt_u32 s25, 1
s_cselect_b32 s38, s29, 0
s_add_u32 s36, s36, s38
s_add_u32 s37, s37, s29
s_cmp_gt_u32 s25, 2
s_cselect_b32 s38, s30, 0
s_add_u32 s36, s36, s38
s_add_u32 s37, s37, s30
s_cmp_gt_u32 s25, 3
s_cselect_b32 s38, s31, 0
s_add_u32 s36, s36, s38
s_add_u32 s37, s37, s31
s_cmp_gt_u32 s25, 4
s_cselect_b32 s38, s32, 0
s_add_u32 s36, s36, s38
s_add_u32 s37, s37, s32
s_cmp_gt_u32 s25, 5
s_cselect_b32 s38, s33, 0
s_add_u32 s36, s36, s38
s_add_u32 s37, s37, s33
s_cmp_gt_u32 s25, 6
s_cselect_b32 s38, s34, 0
s_add_u32 s36, s36, s38
s_add_u32 s37, s37, s34
s_cmp_gt_u32 s25, 7
s_cselect_b32 s38, s35, 0
s_add_u32 s36, s36, s38
s_add_u32 s37, s37, s35
v_sub_u32 v9, v9, v8
v_add_u32 v9, s36, v9
v_lshlrev_b32 v10, 12, v0
v_add_u32 v10, v10, v6
v_sub_u32 v10, v10, v9
v_lshlrev_b32 v11, 2, v0
v_cmp_gt_u32 vcc, 256, v0
s_and_saveexec_b64 s[26:27], vcc
ds_write_b32 v11, v9 offset:1024
ds_write_b32 v11, v10 offset:2048
s_mov_b64 exec, s[26:27]
v_mov_b32 v40, 0
v_mov_b32 v41, 0
v_mov_b32 v42, 0
v_mov_b32 v43, 0
v_mov_b32 v44, 0
v_mov_b32 v45, 0
v_mov_b32 v46, 0
v_mov_b32 v47, 0
s_mov_b32 s39, 0
K2_BATCH:
v_mov_b32 v12, 0
v_cmp_gt_u32 vcc, 64, v0
s_and_saveexec_b64 s[26:27], vcc
ds_write_b32 v11, v12 offset:0
s_mov_b64 exec, s[26:27]
s_sub_u32 s40, s37, s39
s_min_u32 s40, s40, 2048
s_waitcnt lgkmcnt(0)
s_barrier
s_mov_b32 s41, 0
K2_PB:
v_add_u32 v12, s41, v0
v_cmp_gt_u32 vcc, s40, v12
s_and_saveexec_b64 s[26:27], vcc
s_cbranch_execz K2_PB_SKIP
v_add_u32 v13, s39, v12
v_mov_b32 v14, 0
v_add_u32 v15, 128, v14
v_lshlrev_b32 v16, 2, v15
ds_read_b32 v16, v16 offset:1024
s_waitcnt lgkmcnt(0)
v_cmp_le_u32 vcc, v16, v13
s_nop 1
v_cndmask_b32 v14, v14, v15, vcc
v_add_u32 v15, 64, v14
v_lshlrev_b32 v16, 2, v15
ds_read_b32 v16, v16 offset:1024
s_waitcnt lgkmcnt(0)
v_cmp_le_u32 vcc, v16, v13
s_nop 1
v_cndmask_b32 v14, v14, v15, vcc
v_add_u32 v15, 32, v14
v_lshlrev_b32 v16, 2, v15
ds_read_b32 v16, v16 offset:1024
s_waitcnt lgkmcnt(0)
v_cmp_le_u32 vcc, v16, v13
s_nop 1
v_cndmask_b32 v14, v14, v15, vcc
v_add_u32 v15, 16, v14
v_lshlrev_b32 v16, 2, v15
ds_read_b32 v16, v16 offset:1024
s_waitcnt lgkmcnt(0)
v_cmp_le_u32 vcc, v16, v13
s_nop 1
v_cndmask_b32 v14, v14, v15, vcc
v_add_u32 v15, 8, v14
v_lshlrev_b32 v16, 2, v15
ds_read_b32 v16, v16 offset:1024
s_waitcnt lgkmcnt(0)
v_cmp_le_u32 vcc, v16, v13
s_nop 1
v_cndmask_b32 v14, v14, v15, vcc
v_add_u32 v15, 4, v14
v_lshlrev_b32 v16, 2, v15
ds_read_b32 v16, v16 offset:1024
s_waitcnt lgkmcnt(0)
v_cmp_le_u32 vcc, v16, v13
s_nop 1
v_cndmask_b32 v14, v14, v15, vcc
v_add_u32 v15, 2, v14
v_lshlrev_b32 v16, 2, v15
ds_read_b32 v16, v16 offset:1024
s_waitcnt lgkmcnt(0)
v_cmp_le_u32 vcc, v16, v13
s_nop 1
v_cndmask_b32 v14, v14, v15, vcc
v_add_u32 v15, 1, v14
v_lshlrev_b32 v16, 2, v15
ds_read_b32 v16, v16 offset:1024
s_waitcnt lgkmcnt(0)
v_cmp_le_u32 vcc, v16, v13
s_nop 1
v_cndmask_b32 v14, v14, v15, vcc
v_lshlrev_b32 v16, 2, v14
ds_read_b32 v16, v16 offset:2048
s_waitcnt lgkmcnt(0)
v_add_u32 v16, v16, v13
v_lshlrev_b32 v16, 3, v16
buffer_load_dwordx2 v[18:19], v16, s[16:19], 0 offen
v_mov_b32 v20, 1
s_waitcnt vmcnt(0)
v_lshlrev_b32 v21, 2, v19
ds_add_rtn_u32 v22, v21, v20 offset:0
s_waitcnt lgkmcnt(0)
v_lshl_or_b32 v19, v22, 6, v19
v_lshlrev_b32 v21, 3, v12
ds_write_b64 v21, v[18:19] offset:4096
K2_PB_SKIP:
s_mov_b64 exec, s[26:27]
s_add_u32 s41, s41, 512
s_cmp_lt_u32 s41, s40
s_cbranch_scc1 K2_PB
s_waitcnt lgkmcnt(0)
s_barrier
s_cmp_lg_u32 s25, 0
s_cbranch_scc1 K2_SCAN_DONE
v_lshlrev_b32 v12, 2, v1
ds_read_b32 v13, v12 offset:0
s_waitcnt lgkmcnt(0)
v_mov_b32 v14, v13
s_nop 1
v_add_u32_dpp v14, v14, v14 row_shr:1 row_mask:0xf bank_mask:0xf bound_ctrl:0
s_nop 1
v_add_u32_dpp v14, v14, v14 row_shr:2 row_mask:0xf bank_mask:0xf bound_ctrl:0
s_nop 1
v_add_u32_dpp v14, v14, v14 row_shr:4 row_mask:0xf bank_mask:0xf bound_ctrl:0
s_nop 1
v_add_u32_dpp v14, v14, v14 row_shr:8 row_mask:0xf bank_mask:0xf bound_ctrl:0
s_nop 1
v_add_u32_dpp v14, v14, v14 row_bcast:15 row_mask:0xa bank_mask:0xf
s_nop 1
v_add_u32_dpp v14, v14, v14 row_bcast:31 row_mask:0xc bank_mask:0xf
s_nop 1
v_sub_u32 v14, v14, v13
ds_write_b32 v12, v14 offset:256
s_waitcnt lgkmcnt(0)
K2_SCAN_DONE:
s_barrier
s_mov_b32 s41, 0
K2_PC:
v_add_u32 v12, s41, v0
v_cmp_gt_u32 vcc, s40, v12
s_and_saveexec_b64 s[26:27], vcc
s_cbranch_execz K2_PC_SKIP
v_lshlrev_b32 v13, 3, v12
ds_read_b64 v[14:15], v13 offset:4096
s_waitcnt lgkmcnt(0)
v_and_b32 v16, 63, v15
v_lshlrev_b32 v16, 2, v16
ds_read_b32 v16, v16 offset:256
v_lshrrev_b32 v15, 6, v15
s_waitcnt lgkmcnt(0)
v_add_u32 v16, v16, v15
v_lshlrev_b32 v16, 2, v16
ds_write_b32 v16, v14 offset:20480
K2_PC_SKIP:
s_mov_b64 exec, s[26:27]
s_add_u32 s41, s41, 512
s_cmp_lt_u32 s41, s40
s_cbranch_scc1 K2_PC
s_waitcnt lgkmcnt(0)
s_barrier
v_lshlrev_b32 v12, 2, v3
ds_read_b32 v13, v12 offset:256
ds_read_b32 v14, v12 offset:0
v_lshlrev_b32 v15, 4, v4
v_mov_b32 v16, 0
s_mov_b32 s42, 0xffff0000
v_mov_b32 v17, 0x7ffffff0
s_waitcnt lgkmcnt(0)
v_lshlrev_b32 v13, 2, v13
K2_PD:
v_add_u32 v18, 0, v16
v_lshl_add_u32 v19, v18, 2, v13
ds_read_b32 v24, v19 offset:20480
v_add_u32 v18, 1, v16
v_lshl_add_u32 v19, v18, 2, v13
ds_read_b32 v25, v19 offset:20480
v_add_u32 v18, 2, v16
v_lshl_add_u32 v19, v18, 2, v13
ds_read_b32 v26, v19 offset:20480
v_add_u32 v18, 3, v16
v_lshl_add_u32 v19, v18, 2, v13
ds_read_b32 v27, v19 offset:20480
s_waitcnt lgkmcnt(0)
v_add_u32 v18, 0, v16
v_cmp_lt_u32 vcc, v18, v14
v_and_b32 v19, 0xffff, v24
v_lshl_add_u32 v19, v19, 7, v15
v_cndmask_b32 v19, v17, v19, vcc
v_and_b32 v24, s42, v24
v_cndmask_b32 v24, 0, v24, vcc
buffer_load_dwordx4 v[48:51], v19, s[12:15], 0 offen
v_add_u32 v18, 1, v16
v_cmp_lt_u32 vcc, v18, v14
v_and_b32 v19, 0xffff, v25
v_lshl_add_u32 v19, v19, 7, v15
v_cndmask_b32 v19, v17, v19, vcc
v_and_b32 v25, s42, v25
v_cndmask_b32 v25, 0, v25, vcc
buffer_load_dwordx4 v[52:55], v19, s[12:15], 0 offen
v_add_u32 v18, 2, v16
v_cmp_lt_u32 vcc, v18, v14
v_and_b32 v19, 0xffff, v26
v_lshl_add_u32 v19, v19, 7, v15
v_cndmask_b32 v19, v17, v19, vcc
v_and_b32 v26, s42, v26
v_cndmask_b32 v26, 0, v26, vcc
buffer_load_dwordx4 v[56:59], v19, s[12:15], 0 offen
v_add_u32 v18, 3, v16
v_cmp_lt_u32 vcc, v18, v14
v_and_b32 v19, 0xffff, v27
v_lshl_add_u32 v19, v19, 7, v15
v_cndmask_b32 v19, v17, v19, vcc
v_and_b32 v27, s42, v27
v_cndmask_b32 v27, 0, v27, vcc
buffer_load_dwordx4 v[60:63], v19, s[12:15], 0 offen
s_waitcnt vmcnt(3)
v_lshlrev_b32 v20, 16, v48
v_and_b32 v21, s42, v48
v_fmac_f32 v40, v20, v24
v_fmac_f32 v41, v21, v24
v_lshlrev_b32 v20, 16, v49
v_and_b32 v21, s42, v49
v_fmac_f32 v42, v20, v24
v_fmac_f32 v43, v21, v24
v_lshlrev_b32 v20, 16, v50
v_and_b32 v21, s42, v50
v_fmac_f32 v44, v20, v24
v_fmac_f32 v45, v21, v24
v_lshlrev_b32 v20, 16, v51
v_and_b32 v21, s42, v51
v_fmac_f32 v46, v20, v24
v_fmac_f32 v47, v21, v24
s_waitcnt vmcnt(2)
v_lshlrev_b32 v20, 16, v52
v_and_b32 v21, s42, v52
v_fmac_f32 v40, v20, v25
v_fmac_f32 v41, v21, v25
v_lshlrev_b32 v20, 16, v53
v_and_b32 v21, s42, v53
v_fmac_f32 v42, v20, v25
v_fmac_f32 v43, v21, v25
v_lshlrev_b32 v20, 16, v54
v_and_b32 v21, s42, v54
v_fmac_f32 v44, v20, v25
v_fmac_f32 v45, v21, v25
v_lshlrev_b32 v20, 16, v55
v_and_b32 v21, s42, v55
v_fmac_f32 v46, v20, v25
v_fmac_f32 v47, v21, v25
s_waitcnt vmcnt(1)
v_lshlrev_b32 v20, 16, v56
v_and_b32 v21, s42, v56
v_fmac_f32 v40, v20, v26
v_fmac_f32 v41, v21, v26
v_lshlrev_b32 v20, 16, v57
v_and_b32 v21, s42, v57
v_fmac_f32 v42, v20, v26
v_fmac_f32 v43, v21, v26
v_lshlrev_b32 v20, 16, v58
v_and_b32 v21, s42, v58
v_fmac_f32 v44, v20, v26
v_fmac_f32 v45, v21, v26
v_lshlrev_b32 v20, 16, v59
v_and_b32 v21, s42, v59
v_fmac_f32 v46, v20, v26
v_fmac_f32 v47, v21, v26
s_waitcnt vmcnt(0)
v_lshlrev_b32 v20, 16, v60
v_and_b32 v21, s42, v60
v_fmac_f32 v40, v20, v27
v_fmac_f32 v41, v21, v27
v_lshlrev_b32 v20, 16, v61
v_and_b32 v21, s42, v61
v_fmac_f32 v42, v20, v27
v_fmac_f32 v43, v21, v27
v_lshlrev_b32 v20, 16, v62
v_and_b32 v21, s42, v62
v_fmac_f32 v44, v20, v27
v_fmac_f32 v45, v21, v27
v_lshlrev_b32 v20, 16, v63
v_and_b32 v21, s42, v63
v_fmac_f32 v46, v20, v27
v_fmac_f32 v47, v21, v27
v_add_u32 v16, 4, v16
v_cmp_lt_u32 vcc, v16, v14
s_nop 4
s_cbranch_vccnz K2_PD
K2_NOD:
s_add_u32 s39, s39, 2048
s_cmp_lt_u32 s39, s37
s_cbranch_scc0 K2_OUT
s_barrier
s_branch K2_BATCH
K2_OUT:
v_cvt_pk_bf16_f32 v20, v40, v41
v_cvt_pk_bf16_f32 v21, v42, v43
v_cvt_pk_bf16_f32 v22, v44, v45
v_cvt_pk_bf16_f32 v23, v46, v47
s_lshl_b32 s43, s2, 13
v_lshlrev_b32 v12, 4, v0
buffer_store_dwordx4 v[20:23], v12, s[8:11], s43 offen
K2_END:
s_endpgm
.section .rodata,"a"
.p2align 6
.amdhsa_kernel spmm_k1_kernel
  .amdhsa_next_free_vgpr 112
  .amdhsa_next_free_sgpr 64
  .amdhsa_accum_offset 112
  .amdhsa_group_segment_fixed_size 0
  .amdhsa_kernarg_size 64
  .amdhsa_user_sgpr_count 2
  .amdhsa_user_sgpr_kernarg_segment_ptr 1
  .amdhsa_system_sgpr_workgroup_id_x 1
.end_amdhsa_kernel
.section .rodata,"a"
.p2align 6
.amdhsa_kernel spmm_k2_kernel
  .amdhsa_next_free_vgpr 64
  .amdhsa_next_free_sgpr 64
  .amdhsa_accum_offset 64
  .amdhsa_group_segment_fixed_size 0
  .amdhsa_kernarg_size 64
  .amdhsa_user_sgpr_count 2
  .amdhsa_user_sgpr_kernarg_segment_ptr 1
  .amdhsa_system_sgpr_workgroup_id_x 1
.end_amdhsa_kernel
```
